```python
import torch

def _softmax(x, axis=-1):
    return torch.softmax(x, dim=axis)
def _gelu(x):
    return torch.nn.functional.gelu(x, approximate="tanh")
def _silu(x):
    return torch.nn.functional.silu(x)
def _sigmoid(x):
    return torch.sigmoid(x)
def _layernorm(x, axis=-1, eps=1e-5):
    m = x.mean(dim=axis, keepdim=True)
    v = x.var(dim=axis, keepdim=True, unbiased=False)
    return (x - m) / torch.sqrt(v + eps)
def _scatter_add(tgt, idx, src, axis=0):
    return tgt.clone().index_add_(axis, idx, src)
def _segment_sum(src, seg, n):
    out = torch.zeros((n,) + src.shape[1:], dtype=src.dtype)
    return out.index_add_(0, seg, src)
def _pad(x, pw):
    flat = tuple(v for pair in reversed(pw) for v in pair)
    return torch.nn.functional.pad(x, flat)

kernel_name = 'concat_heads__gqa_block_cached__gqa_block_cached__near_ridge'

def setup_inputs():

    _w = (lambda a: (lambda t: t.to(torch.bfloat16) if t.is_floating_point() else t)(torch.as_tensor(a)))
    def _A_setup():
        B, Sq, D = 32, 32, 640
        Hq, Hkv, Sk, Dh = 32, 32, 32, 128
        assert Hq % Hkv == 0, (Hq, Hkv)
        return {
            "x": _w((lambda *s: torch.randn(*s, dtype=torch.bfloat16) * 0.8)(B, Sq, D)),
            "k_cache": _w((lambda *s: torch.randn(*s, dtype=torch.bfloat16) * 0.8)(B, Hkv, Sk, Dh)),
            "v_cache": _w((lambda *s: torch.randn(*s, dtype=torch.bfloat16) * 0.05)(B, Hkv, Sk, Dh)),
            "wq": _w((lambda *s: torch.randn(*s, dtype=torch.bfloat16) * 0.8)(D, Hq * Dh) * (D ** -0.5)),
            "wo": _w((lambda *s: torch.randn(*s, dtype=torch.bfloat16) * 0.05)(Hq * Dh, D) * ((Hq * Dh) ** -0.5)),
        }
    _A_in = _A_setup()

    def _B_setup():
        B, Sq, D = 32, 32, 640
        Hq, Hkv, Sk, Dh = 32, 32, 32, 128
        assert Hq % Hkv == 0, (Hq, Hkv)
        return {
            "x": _w((lambda *s: torch.randn(*s, dtype=torch.bfloat16) * 0.8)(B, Sq, D)),
            "k_cache": _w((lambda *s: torch.randn(*s, dtype=torch.bfloat16) * 0.8)(B, Hkv, Sk, Dh)),
            "v_cache": _w((lambda *s: torch.randn(*s, dtype=torch.bfloat16) * 0.05)(B, Hkv, Sk, Dh)),
            "wq": _w((lambda *s: torch.randn(*s, dtype=torch.bfloat16) * 0.8)(D, Hq * Dh) * (D ** -0.5)),
            "wo": _w((lambda *s: torch.randn(*s, dtype=torch.bfloat16) * 0.05)(Hq * Dh, D) * ((Hq * Dh) ** -0.5)),
        }
    _B_in = _B_setup()

    return {
        "A_x": _A_in["x"],
        "A_k_cache": _A_in["k_cache"],
        "A_v_cache": _A_in["v_cache"],
        "A_wq": _A_in["wq"],
        "A_wo": _A_in["wo"],
        "B_x": _B_in["x"],
        "B_k_cache": _B_in["k_cache"],
        "B_v_cache": _B_in["v_cache"],
        "B_wq": _B_in["wq"],
        "B_wo": _B_in["wo"],
    }

def reference(A_x, A_k_cache, A_v_cache, A_wq, A_wo, B_x, B_k_cache, B_v_cache, B_wq, B_wo):
    def _A_ref(x, k_cache, v_cache, wq, wo):
        B, Sq, D = x.shape
        Hq, Dh = 32, 128
        Hkv = k_cache.shape[1]
        rep = Hq // Hkv
        q = (lambda x, *d: x.permute(*d))((x @ wq).reshape(B, Sq, Hq, Dh), 0, 2, 1, 3)
        k = (lambda x, n, axis: torch.repeat_interleave(x, n, dim=axis))(k_cache, rep, axis=1)
        v = (lambda x, n, axis: torch.repeat_interleave(x, n, dim=axis))(v_cache, rep, axis=1)
        scores = torch.einsum("bhqd,bhkd->bhqk", q, k) * (Dh ** -0.5)
        p = _softmax(scores, axis=-1)
        o = torch.einsum("bhqk,bhkd->bhqd", p, v)
        return (lambda x, *d: x.permute(*d))(o, 0, 2, 1, 3).reshape(B, Sq, Hq * Dh) @ wo

    def _B_ref(x, k_cache, v_cache, wq, wo):
        B, Sq, D = x.shape
        Hq, Dh = 32, 128
        Hkv = k_cache.shape[1]
        rep = Hq // Hkv
        q = (lambda x, *d: x.permute(*d))((x @ wq).reshape(B, Sq, Hq, Dh), 0, 2, 1, 3)
        k = (lambda x, n, axis: torch.repeat_interleave(x, n, dim=axis))(k_cache, rep, axis=1)
        v = (lambda x, n, axis: torch.repeat_interleave(x, n, dim=axis))(v_cache, rep, axis=1)
        scores = torch.einsum("bhqd,bhkd->bhqk", q, k) * (Dh ** -0.5)
        p = _softmax(scores, axis=-1)
        o = torch.einsum("bhqk,bhkd->bhqd", p, v)
        return (lambda x, *d: x.permute(*d))(o, 0, 2, 1, 3).reshape(B, Sq, Hq * Dh) @ wo

    a = _A_ref(A_x, A_k_cache, A_v_cache, A_wq, A_wo)
    b = _B_ref(B_x, B_k_cache, B_v_cache, B_wq, B_wo)
    return torch.concatenate([a, b], axis=-1)
```

```asm
; @launch grid=(256,1,1) block=(512,1,1) lds=163840
.amdgcn_target "amdgcn-amd-amdhsa--gfx950"
.text
.globl concat_heads__gqa_block_cached__gqa_block_cached__near_ridge_kernel
.p2align 8
.type concat_heads__gqa_block_cached__gqa_block_cached__near_ridge_kernel,@function
concat_heads__gqa_block_cached__gqa_block_cached__near_ridge_kernel:
    s_cmp_ge_u32 s2, 256
    s_cbranch_scc1 L_end
    s_bfe_u32 s18, s2, 0x10002
    s_mul_i32 s3, s18, 40
    s_load_dwordx8 s[8:15], s[0:1], s3
    s_add_u32 s3, s3, 32
    s_load_dwordx2 s[16:17], s[0:1], s3
    s_load_dwordx2 s[32:33], s[0:1], 80
    s_load_dwordx2 s[36:37], s[0:1], 96
    v_lshrrev_b32 v1, 6, v0
    v_and_b32 v2, 63, v0
    v_readfirstlane_b32 s23, v1
    s_and_b32 s19, s2, 3
    s_lshr_b32 s20, s2, 5
    s_bfe_u32 s21, s2, 0x20003
    s_add_u32 s22, s21, s20
    s_and_b32 s22, s22, 3
    s_cmp_lt_u32 s23, 4
    s_cbranch_scc1 L_compute
    s_sub_u32 s39, s23, 4
    v_lshrrev_b32 v3, 3, v2
    s_lshl_b32 s24, s39, 5
    v_add_u32 v3, s24, v3
    v_mul_u32_u24 v3, 1280, v3
    v_and_b32 v4, 7, v2
    v_lshrrev_b32 v5, 4, v2
    v_xor_b32 v4, v4, v5
    v_lshl_add_u32 v6, v4, 4, v3
    v_xor_b32 v7, 64, v6
    v_add_u32 v10, 0, v6
    v_add_u32 v11, 9216, v7
    v_add_u32 v12, 18432, v6
    v_add_u32 v13, 27648, v7
    v_lshrrev_b32 v3, 5, v2
    v_and_b32 v4, 31, v2
    v_lshlrev_b32 v5, 1, v3
    v_xor_b32 v4, v4, v5
    s_lshl_b32 s24, s39, 4
    v_add_u32 v3, s24, v3
    v_lshlrev_b32 v3, 13, v3
    v_lshl_add_u32 v6, v4, 4, v3
    v_add_u32 v14, 0, v6
    v_xor_b32 v7, 64, v6
    v_add_u32 v15, 15360, v7
    v_add_u32 v16, 30720, v6
    v_xor_b32 v7, 64, v6
    v_add_u32 v17, 46080, v7
    v_xor_b32 v7, 128, v6
    v_add_u32 v18, 65536, v7
    v_xor_b32 v7, 192, v6
    v_add_u32 v19, 80896, v7
    v_xor_b32 v7, 128, v6
    v_add_u32 v20, 96256, v7
    v_xor_b32 v7, 192, v6
    v_add_u32 v21, 111616, v7
    s_lshl_b32 s80, s39, 12
    s_lshl_b32 s81, s39, 13
    s_add_u32 s81, s81, 16384
    s_mul_i32 s24, s22, 5
    s_lshr_b32 s24, s24, 1
    s_lshl_b32 s78, s24, 7
    s_mul_i32 s24, s20, 163840
    s_lshl_b32 s25, s19, 2
    s_add_u32 s25, s25, s21
    s_lshl_b32 s25, s25, 9
    s_waitcnt lgkmcnt(0)
    s_add_u32 s44, s14, s25
    s_addc_u32 s45, s15, 0
    s_sub_u32 s46, 5242880, s25
    s_mov_b32 s47, 0x20000
    s_add_u32 s40, s8, s24
    s_addc_u32 s41, s9, 0
    s_sub_u32 s42, 1310720, s24
    s_mov_b32 s43, 0x20000
    s_lshl_b32 s79, s78, 12
    s_add_u32 m0, s81, 49152
    s_nop 0
    buffer_load_dwordx4 v14, s[44:47], s79 offen offset:0 lds
    buffer_load_dwordx4 v15, s[44:47], s79 offen offset:1024 lds
    buffer_load_dwordx4 v16, s[44:47], s79 offen offset:2048 lds
    buffer_load_dwordx4 v17, s[44:47], s79 offen offset:3072 lds
    s_add_u32 m0, m0, 4096
    s_nop 0
    buffer_load_dwordx4 v18, s[44:47], s79 offen offset:0 lds
    buffer_load_dwordx4 v19, s[44:47], s79 offen offset:1024 lds
    buffer_load_dwordx4 v20, s[44:47], s79 offen offset:2048 lds
    buffer_load_dwordx4 v21, s[44:47], s79 offen offset:3072 lds
    s_add_u32 m0, s80, 49152
    s_nop 0
    buffer_load_dwordx4 v10, s[40:43], s78 offen offset:0 lds
    buffer_load_dwordx4 v11, s[40:43], s78 offen offset:1024 lds
    buffer_load_dwordx4 v12, s[40:43], s78 offen offset:2048 lds
    buffer_load_dwordx4 v13, s[40:43], s78 offen offset:3072 lds
    s_add_u32 s78, s78, 128
    s_cmp_eq_u32 s78, 1280
    s_cselect_b32 s78, 0, s78
    s_lshl_b32 s76, s20, 7
    s_lshl_b32 s24, s19, 3
    s_add_u32 s76, s76, s24
    s_lshl_b32 s24, s76, 13
    s_add_u32 s52, s12, s24
    s_addc_u32 s53, s13, 0
    s_sub_u32 s54, 8388608, s24
    s_mov_b32 s55, 0x20000
    s_lshl_b32 s25, s21, 14
    s_add_u32 s24, s24, s25
    s_add_u32 s48, s10, s24
    s_addc_u32 s49, s11, 0
    s_sub_u32 s50, 8388608, s24
    s_mov_b32 s51, 0x20000
    s_mul_i32 s24, s19, 1310720
    s_mul_i32 s25, s22, 320
    s_add_u32 s24, s24, s25
    s_add_u32 s56, s16, s24
    s_addc_u32 s57, s17, 0
    s_sub_u32 s58, 5242880, s24
    s_mov_b32 s59, 0x20000
    s_lshl_b32 s24, s18, 10
    s_add_u32 s24, s24, s76
    s_lshl_b32 s24, s24, 11
    s_add_u32 s60, s36, s24
    s_addc_u32 s61, s37, 0
    s_sub_u32 s62, 4194304, s24
    s_mov_b32 s63, 0x20000
    s_and_b32 s24, s2, 0xfc
    s_mul_i32 s24, s24, 40960
    s_add_u32 s24, s24, 4194304
    s_add_u32 s64, s36, s24
    s_addc_u32 s65, s37, 0
    s_sub_u32 s66, 14680064, s24
    s_mov_b32 s67, 0x20000
    s_mov_b32 s24, 16777216
    s_add_u32 s72, s36, s24
    s_addc_u32 s73, s37, 0
    s_sub_u32 s74, 16943104, s24
    s_mov_b32 s75, 0x20000
    s_lshr_b32 s24, s19, 1
    s_lshl_b32 s25, s20, 1
    s_add_u32 s24, s24, s25
    s_mul_i32 s24, s24, 163840
    s_lshl_b32 s25, s18, 2
    s_add_u32 s25, s25, s22
    s_lshl_b32 s25, s25, 1
    s_and_b32 s76, s19, 1
    s_add_u32 s25, s25, s76
    s_mul_i32 s25, s25, 160
    s_add_u32 s24, s24, s25
    s_add_u32 s68, s32, s24
    s_addc_u32 s69, s33, 0
    s_sub_u32 s70, 2621440, s24
    s_mov_b32 s71, 0x20000
    s_lshl_b32 s24, s18, 3
    s_add_u32 s24, s24, s20
    s_lshl_b32 s24, s24, 7
    s_add_u32 s26, s24, 163840
    s_load_dword s27, s[72:73], s26
    s_and_b32 s82, s39, 1
    s_lshr_b32 s83, s39, 1
    s_lshl_b32 s84, s83, 6
    s_add_u32 s84, s84, s82
    s_lshl_b32 s84, s84, 13
    s_lshl_b32 s82, s82, 1
    s_add_u32 s82, s82, s83
    s_lshl_b32 s82, s82, 12
    s_add_u32 s85, s82, 98304
    v_lshrrev_b32 v3, 4, v2
    v_and_b32 v4, 15, v2
    v_xor_b32 v4, v3, v4
    v_lshlrev_b32 v4, 4, v4
    v_lshl_add_u32 v22, v3, 8, v4
    v_xor_b32 v23, 64, v22
    v_xor_b32 v24, 128, v22
    v_xor_b32 v25, 192, v22
    v_lshlrev_b32 v38, 4, v2
    s_mul_i32 s24, s39, 20480
    s_mov_b32 s25, 52429
    v_add_u32 v3, 0, v2
    v_mul_u32_u24 v4, s25, v3
    v_lshrrev_b32 v4, 20, v4
    v_and_b32 v5, 8, v4
    v_lshrrev_b32 v5, 2, v5
    v_xor_b32 v3, v3, v5
    v_mul_u32_u24 v4, 960, v4
    v_lshl_add_u32 v4, v3, 4, v4
    v_add_u32 v4, s24, v4
    v_subrev_u32 v26, 0, v4
    v_add_u32 v3, 64, v2
    v_mul_u32_u24 v4, s25, v3
    v_lshrrev_b32 v4, 20, v4
    v_and_b32 v5, 8, v4
    v_lshrrev_b32 v5, 2, v5
    v_xor_b32 v3, v3, v5
    v_mul_u32_u24 v4, 960, v4
    v_lshl_add_u32 v4, v3, 4, v4
    v_add_u32 v4, s24, v4
    v_subrev_u32 v27, 1024, v4
    v_add_u32 v3, 128, v2
    v_mul_u32_u24 v4, s25, v3
    v_lshrrev_b32 v4, 20, v4
    v_and_b32 v5, 8, v4
    v_lshrrev_b32 v5, 2, v5
    v_xor_b32 v3, v3, v5
    v_mul_u32_u24 v4, 960, v4
    v_lshl_add_u32 v4, v3, 4, v4
    v_add_u32 v4, s24, v4
    v_subrev_u32 v28, 2048, v4
    v_add_u32 v3, 192, v2
    v_mul_u32_u24 v4, s25, v3
    v_lshrrev_b32 v4, 20, v4
    v_and_b32 v5, 8, v4
    v_lshrrev_b32 v5, 2, v5
    v_xor_b32 v3, v3, v5
    v_mul_u32_u24 v4, 960, v4
    v_lshl_add_u32 v4, v3, 4, v4
    v_add_u32 v4, s24, v4
    v_subrev_u32 v29, 3072, v4
    v_add_u32 v3, 256, v2
    v_mul_u32_u24 v4, s25, v3
    v_lshrrev_b32 v4, 20, v4
    v_and_b32 v5, 8, v4
    v_lshrrev_b32 v5, 2, v5
    v_xor_b32 v3, v3, v5
    v_mul_u32_u24 v4, 960, v4
    v_lshl_add_u32 v4, v3, 4, v4
    v_add_u32 v4, s24, v4
    v_subrev_u32 v30, 0, v4
    v_lshrrev_b32 v3, 3, v2
    v_lshlrev_b32 v3, 8, v3
    s_lshl_b32 s24, s39, 18
    v_add_u32 v3, s24, v3
    v_and_b32 v4, 7, v2
    v_lshrrev_b32 v5, 4, v2
    v_xor_b32 v4, v4, v5
    v_lshl_add_u32 v6, v4, 4, v3
    v_xor_b32 v7, 64, v6
    v_add_u32 v32, 0, v6
    v_add_u32 v33, 1024, v7
    v_add_u32 v34, 2048, v6
    v_add_u32 v35, 3072, v7
    s_lshl_b32 s24, s39, 16
    v_add_u32 v36, s24, v38
    v_and_b32 v39, 3, v2
    v_lshlrev_b32 v39, 2, v39
    s_mul_i32 s4, s39, 5120
    s_lshl_b32 s5, s39, 12
    s_add_u32 s5, s5, 20480
    s_lshl_b32 s6, s39, 11
    s_add_u32 s6, s6, 147456
    s_lshl_b32 s7, s21, 1
    s_lshl_b32 s24, s20, 3
    s_and_b32 s25, s2, 7
    s_add_u32 s24, s24, s25
    s_lshl_b32 s24, s24, 2
    s_add_u32 s24, s24, s39
    s_lshl_b32 s87, s24, 7
    v_add_u32 v37, s5, v38
    s_lshl_b32 s79, s78, 12
    s_add_u32 m0, s81, 98304
    s_nop 0
    buffer_load_dwordx4 v14, s[44:47], s79 offen offset:0 lds
    buffer_load_dwordx4 v15, s[44:47], s79 offen offset:1024 lds
    buffer_load_dwordx4 v16, s[44:47], s79 offen offset:2048 lds
    buffer_load_dwordx4 v17, s[44:47], s79 offen offset:3072 lds
    s_add_u32 m0, m0, 4096
    s_nop 0
    buffer_load_dwordx4 v18, s[44:47], s79 offen offset:0 lds
    buffer_load_dwordx4 v19, s[44:47], s79 offen offset:1024 lds
    buffer_load_dwordx4 v20, s[44:47], s79 offen offset:2048 lds
    buffer_load_dwordx4 v21, s[44:47], s79 offen offset:3072 lds
    s_add_u32 m0, s80, 98304
    s_nop 0
    buffer_load_dwordx4 v10, s[40:43], s78 offen offset:0 lds
    buffer_load_dwordx4 v11, s[40:43], s78 offen offset:1024 lds
    buffer_load_dwordx4 v12, s[40:43], s78 offen offset:2048 lds
    buffer_load_dwordx4 v13, s[40:43], s78 offen offset:3072 lds
    s_add_u32 s78, s78, 128
    s_cmp_eq_u32 s78, 1280
    s_cselect_b32 s78, 0, s78
    s_waitcnt lgkmcnt(0)
    s_mul_i32 s27, s27, 0x9E3779B1
    s_add_u32 s27, s27, 0x7F4A7C15
    s_and_b32 s24, s20, 1
    s_cmp_eq_u32 s24, 1
    s_cbranch_scc1 L_kg1
    s_waitcnt vmcnt(12)
    s_barrier
    s_lshl_b32 s79, s78, 12
    s_add_u32 m0, s81, 0
    s_nop 0
    buffer_load_dwordx4 v14, s[44:47], s79 offen offset:0 lds
    buffer_load_dwordx4 v15, s[44:47], s79 offen offset:1024 lds
    buffer_load_dwordx4 v16, s[44:47], s79 offen offset:2048 lds
    buffer_load_dwordx4 v17, s[44:47], s79 offen offset:3072 lds
    s_add_u32 m0, m0, 4096
    s_nop 0
    buffer_load_dwordx4 v18, s[44:47], s79 offen offset:0 lds
    buffer_load_dwordx4 v19, s[44:47], s79 offen offset:1024 lds
    buffer_load_dwordx4 v20, s[44:47], s79 offen offset:2048 lds
    buffer_load_dwordx4 v21, s[44:47], s79 offen offset:3072 lds
    s_add_u32 m0, s80, 0
    s_nop 0
    buffer_load_dwordx4 v10, s[40:43], s78 offen offset:0 lds
    buffer_load_dwordx4 v11, s[40:43], s78 offen offset:1024 lds
    buffer_load_dwordx4 v12, s[40:43], s78 offen offset:2048 lds
    buffer_load_dwordx4 v13, s[40:43], s78 offen offset:3072 lds
    s_add_u32 s78, s78, 128
    s_cmp_eq_u32 s78, 1280
    s_cselect_b32 s78, 0, s78
    s_add_u32 s24, s84, 266240
    s_add_u32 m0, s85, 49152
    s_nop 0
    buffer_load_dwordx4 v22, s[48:51], s24 offen offset:0 nt lds
    buffer_load_dwordx4 v23, s[48:51], s24 offen offset:1024 nt lds
    buffer_load_dwordx4 v24, s[48:51], s24 offen offset:2048 nt lds
    buffer_load_dwordx4 v25, s[48:51], s24 offen offset:3072 nt lds
    s_add_u32 s24, s84, 0
    buffer_load_dwordx4 v[64:67], v22, s[48:51], s24 offen offset:0 nt
    buffer_load_dwordx4 v[68:71], v23, s[48:51], s24 offen offset:1024 nt
    buffer_load_dwordx4 v[72:75], v24, s[48:51], s24 offen offset:2048 nt
    buffer_load_dwordx4 v[76:79], v25, s[48:51], s24 offen offset:3072 nt
    s_waitcnt vmcnt(20)
    s_barrier
    s_lshl_b32 s79, s78, 12
    s_add_u32 m0, s81, 49152
    s_nop 0
    buffer_load_dwordx4 v14, s[44:47], s79 offen offset:0 lds
    buffer_load_dwordx4 v15, s[44:47], s79 offen offset:1024 lds
    buffer_load_dwordx4 v16, s[44:47], s79 offen offset:2048 lds
    buffer_load_dwordx4 v17, s[44:47], s79 offen offset:3072 lds
    s_add_u32 m0, m0, 4096
    s_nop 0
    buffer_load_dwordx4 v18, s[44:47], s79 offen offset:0 lds
    buffer_load_dwordx4 v19, s[44:47], s79 offen offset:1024 lds
    buffer_load_dwordx4 v20, s[44:47], s79 offen offset:2048 lds
    buffer_load_dwordx4 v21, s[44:47], s79 offen offset:3072 lds
    s_add_u32 m0, s80, 49152
    s_nop 0
    buffer_load_dwordx4 v10, s[40:43], s78 offen offset:0 lds
    buffer_load_dwordx4 v11, s[40:43], s78 offen offset:1024 lds
    buffer_load_dwordx4 v12, s[40:43], s78 offen offset:2048 lds
    buffer_load_dwordx4 v13, s[40:43], s78 offen offset:3072 lds
    s_add_u32 s78, s78, 128
    s_cmp_eq_u32 s78, 1280
    s_cselect_b32 s78, 0, s78
    s_waitcnt vmcnt(20)
    s_barrier
    s_lshl_b32 s79, s78, 12
    s_add_u32 m0, s81, 98304
    s_nop 0
    buffer_load_dwordx4 v14, s[44:47], s79 offen offset:0 lds
    buffer_load_dwordx4 v15, s[44:47], s79 offen offset:1024 lds
    buffer_load_dwordx4 v16, s[44:47], s79 offen offset:2048 lds
    buffer_load_dwordx4 v17, s[44:47], s79 offen offset:3072 lds
    s_add_u32 m0, m0, 4096
    s_nop 0
    buffer_load_dwordx4 v18, s[44:47], s79 offen offset:0 lds
    buffer_load_dwordx4 v19, s[44:47], s79 offen offset:1024 lds
    buffer_load_dwordx4 v20, s[44:47], s79 offen offset:2048 lds
    buffer_load_dwordx4 v21, s[44:47], s79 offen offset:3072 lds
    s_add_u32 m0, s80, 98304
    s_nop 0
    buffer_load_dwordx4 v10, s[40:43], s78 offen offset:0 lds
    buffer_load_dwordx4 v11, s[40:43], s78 offen offset:1024 lds
    buffer_load_dwordx4 v12, s[40:43], s78 offen offset:2048 lds
    buffer_load_dwordx4 v13, s[40:43], s78 offen offset:3072 lds
    s_add_u32 s78, s78, 128
    s_cmp_eq_u32 s78, 1280
    s_cselect_b32 s78, 0, s78
    s_add_u32 s24, s84, 4096
    buffer_load_dwordx4 v[80:83], v22, s[48:51], s24 offen offset:0 nt
    buffer_load_dwordx4 v[84:87], v23, s[48:51], s24 offen offset:1024 nt
    buffer_load_dwordx4 v[88:91], v24, s[48:51], s24 offen offset:2048 nt
    buffer_load_dwordx4 v[92:95], v25, s[48:51], s24 offen offset:3072 nt
    s_add_u32 s24, s84, 262144
    buffer_load_dwordx4 v[96:99], v22, s[48:51], s24 offen offset:0 nt
    buffer_load_dwordx4 v[100:103], v23, s[48:51], s24 offen offset:1024 nt
    buffer_load_dwordx4 v[104:107], v24, s[48:51], s24 offen offset:2048 nt
    buffer_load_dwordx4 v[108:111], v25, s[48:51], s24 offen offset:3072 nt
    s_waitcnt vmcnt(20)
    s_barrier
    s_lshl_b32 s79, s78, 12
    s_add_u32 m0, s81, 0
    s_nop 0
    buffer_load_dwordx4 v14, s[44:47], s79 offen offset:0 lds
    buffer_load_dwordx4 v15, s[44:47], s79 offen offset:1024 lds
    buffer_load_dwordx4 v16, s[44:47], s79 offen offset:2048 lds
    buffer_load_dwordx4 v17, s[44:47], s79 offen offset:3072 lds
    s_add_u32 m0, m0, 4096
    s_nop 0
    buffer_load_dwordx4 v18, s[44:47], s79 offen offset:0 lds
    buffer_load_dwordx4 v19, s[44:47], s79 offen offset:1024 lds
    buffer_load_dwordx4 v20, s[44:47], s79 offen offset:2048 lds
    buffer_load_dwordx4 v21, s[44:47], s79 offen offset:3072 lds
    s_add_u32 m0, s80, 0
    s_nop 0
    buffer_load_dwordx4 v10, s[40:43], s78 offen offset:0 lds
    buffer_load_dwordx4 v11, s[40:43], s78 offen offset:1024 lds
    buffer_load_dwordx4 v12, s[40:43], s78 offen offset:2048 lds
    buffer_load_dwordx4 v13, s[40:43], s78 offen offset:3072 lds
    s_add_u32 s78, s78, 128
    s_cmp_eq_u32 s78, 1280
    s_cselect_b32 s78, 0, s78
    s_waitcnt vmcnt(20)
    s_barrier
    s_lshl_b32 s79, s78, 12
    s_add_u32 m0, s81, 49152
    s_nop 0
    buffer_load_dwordx4 v14, s[44:47], s79 offen offset:0 lds
    buffer_load_dwordx4 v15, s[44:47], s79 offen offset:1024 lds
    buffer_load_dwordx4 v16, s[44:47], s79 offen offset:2048 lds
    buffer_load_dwordx4 v17, s[44:47], s79 offen offset:3072 lds
    s_add_u32 m0, m0, 4096
    s_nop 0
    buffer_load_dwordx4 v18, s[44:47], s79 offen offset:0 lds
    buffer_load_dwordx4 v19, s[44:47], s79 offen offset:1024 lds
    buffer_load_dwordx4 v20, s[44:47], s79 offen offset:2048 lds
    buffer_load_dwordx4 v21, s[44:47], s79 offen offset:3072 lds
    s_add_u32 m0, s80, 49152
    s_nop 0
    buffer_load_dwordx4 v10, s[40:43], s78 offen offset:0 lds
    buffer_load_dwordx4 v11, s[40:43], s78 offen offset:1024 lds
    buffer_load_dwordx4 v12, s[40:43], s78 offen offset:2048 lds
    buffer_load_dwordx4 v13, s[40:43], s78 offen offset:3072 lds
    s_add_u32 s78, s78, 128
    s_cmp_eq_u32 s78, 1280
    s_cselect_b32 s78, 0, s78
    s_add_u32 s24, s7, 0
    s_and_b32 s24, s24, 7
    s_lshl_b32 s24, s24, 13
    buffer_load_dwordx4 v[128:131], v32, s[52:55], s24 offen offset:0
    buffer_load_dwordx4 v[132:135], v33, s[52:55], s24 offen offset:1024
    buffer_load_dwordx4 v[136:139], v34, s[52:55], s24 offen offset:2048
    buffer_load_dwordx4 v[140:143], v35, s[52:55], s24 offen offset:3072
    s_add_u32 s24, s7, 0
    s_and_b32 s24, s24, 7
    s_lshl_b32 s24, s24, 13
    s_add_u32 s24, s24, 128
    buffer_load_dwordx4 v[144:147], v32, s[52:55], s24 offen offset:0
    buffer_load_dwordx4 v[148:151], v33, s[52:55], s24 offen offset:1024
    buffer_load_dwordx4 v[152:155], v34, s[52:55], s24 offen offset:2048
    buffer_load_dwordx4 v[156:159], v35, s[52:55], s24 offen offset:3072
    s_waitcnt vmcnt(20)
    s_barrier
    s_lshl_b32 s79, s78, 12
    s_add_u32 m0, s81, 98304
    s_nop 0
    buffer_load_dwordx4 v14, s[44:47], s79 offen offset:0 lds
    buffer_load_dwordx4 v15, s[44:47], s79 offen offset:1024 lds
    buffer_load_dwordx4 v16, s[44:47], s79 offen offset:2048 lds
    buffer_load_dwordx4 v17, s[44:47], s79 offen offset:3072 lds
    s_add_u32 m0, m0, 4096
    s_nop 0
    buffer_load_dwordx4 v18, s[44:47], s79 offen offset:0 lds
    buffer_load_dwordx4 v19, s[44:47], s79 offen offset:1024 lds
    buffer_load_dwordx4 v20, s[44:47], s79 offen offset:2048 lds
    buffer_load_dwordx4 v21, s[44:47], s79 offen offset:3072 lds
    s_add_u32 m0, s80, 98304
    s_nop 0
    buffer_load_dwordx4 v10, s[40:43], s78 offen offset:0 lds
    buffer_load_dwordx4 v11, s[40:43], s78 offen offset:1024 lds
    buffer_load_dwordx4 v12, s[40:43], s78 offen offset:2048 lds
    buffer_load_dwordx4 v13, s[40:43], s78 offen offset:3072 lds
    s_add_u32 s78, s78, 128
    s_cmp_eq_u32 s78, 1280
    s_cselect_b32 s78, 0, s78
    s_waitcnt vmcnt(20)
    s_barrier
    s_lshl_b32 s79, s78, 12
    s_add_u32 m0, s81, 0
    s_nop 0
    buffer_load_dwordx4 v14, s[44:47], s79 offen offset:0 lds
    buffer_load_dwordx4 v15, s[44:47], s79 offen offset:1024 lds
    buffer_load_dwordx4 v16, s[44:47], s79 offen offset:2048 lds
    buffer_load_dwordx4 v17, s[44:47], s79 offen offset:3072 lds
    s_add_u32 m0, m0, 4096
    s_nop 0
    buffer_load_dwordx4 v18, s[44:47], s79 offen offset:0 lds
    buffer_load_dwordx4 v19, s[44:47], s79 offen offset:1024 lds
    buffer_load_dwordx4 v20, s[44:47], s79 offen offset:2048 lds
    buffer_load_dwordx4 v21, s[44:47], s79 offen offset:3072 lds
    s_add_u32 m0, s80, 0
    s_nop 0
    buffer_load_dwordx4 v10, s[40:43], s78 offen offset:0 lds
    buffer_load_dwordx4 v11, s[40:43], s78 offen offset:1024 lds
    buffer_load_dwordx4 v12, s[40:43], s78 offen offset:2048 lds
    buffer_load_dwordx4 v13, s[40:43], s78 offen offset:3072 lds
    s_add_u32 s78, s78, 128
    s_cmp_eq_u32 s78, 1280
    s_cselect_b32 s78, 0, s78
    s_waitcnt vmcnt(12)
    s_barrier
    s_lshl_b32 s79, s78, 12
    s_add_u32 m0, s81, 49152
    s_nop 0
    buffer_load_dwordx4 v14, s[44:47], s79 offen offset:0 lds
    buffer_load_dwordx4 v15, s[44:47], s79 offen offset:1024 lds
    buffer_load_dwordx4 v16, s[44:47], s79 offen offset:2048 lds
    buffer_load_dwordx4 v17, s[44:47], s79 offen offset:3072 lds
    s_add_u32 m0, m0, 4096
    s_nop 0
    buffer_load_dwordx4 v18, s[44:47], s79 offen offset:0 lds
    buffer_load_dwordx4 v19, s[44:47], s79 offen offset:1024 lds
    buffer_load_dwordx4 v20, s[44:47], s79 offen offset:2048 lds
    buffer_load_dwordx4 v21, s[44:47], s79 offen offset:3072 lds
    s_add_u32 m0, s80, 49152
    s_nop 0
    buffer_load_dwordx4 v10, s[40:43], s78 offen offset:0 lds
    buffer_load_dwordx4 v11, s[40:43], s78 offen offset:1024 lds
    buffer_load_dwordx4 v12, s[40:43], s78 offen offset:2048 lds
    buffer_load_dwordx4 v13, s[40:43], s78 offen offset:3072 lds
    s_waitcnt vmcnt(12)
    s_barrier
    s_branch L_kjoin
L_kg1:
    s_waitcnt vmcnt(12)
    s_barrier
    s_lshl_b32 s79, s78, 12
    s_add_u32 m0, s81, 0
    s_nop 0
    buffer_load_dwordx4 v14, s[44:47], s79 offen offset:0 lds
    buffer_load_dwordx4 v15, s[44:47], s79 offen offset:1024 lds
    buffer_load_dwordx4 v16, s[44:47], s79 offen offset:2048 lds
    buffer_load_dwordx4 v17, s[44:47], s79 offen offset:3072 lds
    s_add_u32 m0, m0, 4096
    s_nop 0
    buffer_load_dwordx4 v18, s[44:47], s79 offen offset:0 lds
    buffer_load_dwordx4 v19, s[44:47], s79 offen offset:1024 lds
    buffer_load_dwordx4 v20, s[44:47], s79 offen offset:2048 lds
    buffer_load_dwordx4 v21, s[44:47], s79 offen offset:3072 lds
    s_add_u32 m0, s80, 0
    s_nop 0
    buffer_load_dwordx4 v10, s[40:43], s78 offen offset:0 lds
    buffer_load_dwordx4 v11, s[40:43], s78 offen offset:1024 lds
    buffer_load_dwordx4 v12, s[40:43], s78 offen offset:2048 lds
    buffer_load_dwordx4 v13, s[40:43], s78 offen offset:3072 lds
    s_add_u32 s78, s78, 128
    s_cmp_eq_u32 s78, 1280
    s_cselect_b32 s78, 0, s78
    s_waitcnt vmcnt(12)
    s_barrier
    s_lshl_b32 s79, s78, 12
    s_add_u32 m0, s81, 49152
    s_nop 0
    buffer_load_dwordx4 v14, s[44:47], s79 offen offset:0 lds
    buffer_load_dwordx4 v15, s[44:47], s79 offen offset:1024 lds
    buffer_load_dwordx4 v16, s[44:47], s79 offen offset:2048 lds
    buffer_load_dwordx4 v17, s[44:47], s79 offen offset:3072 lds
    s_add_u32 m0, m0, 4096
    s_nop 0
    buffer_load_dwordx4 v18, s[44:47], s79 offen offset:0 lds
    buffer_load_dwordx4 v19, s[44:47], s79 offen offset:1024 lds
    buffer_load_dwordx4 v20, s[44:47], s79 offen offset:2048 lds
    buffer_load_dwordx4 v21, s[44:47], s79 offen offset:3072 lds
    s_add_u32 m0, s80, 49152
    s_nop 0
    buffer_load_dwordx4 v10, s[40:43], s78 offen offset:0 lds
    buffer_load_dwordx4 v11, s[40:43], s78 offen offset:1024 lds
    buffer_load_dwordx4 v12, s[40:43], s78 offen offset:2048 lds
    buffer_load_dwordx4 v13, s[40:43], s78 offen offset:3072 lds
    s_add_u32 s78, s78, 128
    s_cmp_eq_u32 s78, 1280
    s_cselect_b32 s78, 0, s78
    s_add_u32 s24, s84, 266240
    s_add_u32 m0, s85, 49152
    s_nop 0
    buffer_load_dwordx4 v22, s[48:51], s24 offen offset:0 nt lds
    buffer_load_dwordx4 v23, s[48:51], s24 offen offset:1024 nt lds
    buffer_load_dwordx4 v24, s[48:51], s24 offen offset:2048 nt lds
    buffer_load_dwordx4 v25, s[48:51], s24 offen offset:3072 nt lds
    s_add_u32 s24, s84, 0
    buffer_load_dwordx4 v[64:67], v22, s[48:51], s24 offen offset:0 nt
    buffer_load_dwordx4 v[68:71], v23, s[48:51], s24 offen offset:1024 nt
    buffer_load_dwordx4 v[72:75], v24, s[48:51], s24 offen offset:2048 nt
    buffer_load_dwordx4 v[76:79], v25, s[48:51], s24 offen offset:3072 nt
    s_waitcnt vmcnt(20)
    s_barrier
    s_lshl_b32 s79, s78, 12
    s_add_u32 m0, s81, 98304
    s_nop 0
    buffer_load_dwordx4 v14, s[44:47], s79 offen offset:0 lds
    buffer_load_dwordx4 v15, s[44:47], s79 offen offset:1024 lds
    buffer_load_dwordx4 v16, s[44:47], s79 offen offset:2048 lds
    buffer_load_dwordx4 v17, s[44:47], s79 offen offset:3072 lds
    s_add_u32 m0, m0, 4096
    s_nop 0
    buffer_load_dwordx4 v18, s[44:47], s79 offen offset:0 lds
    buffer_load_dwordx4 v19, s[44:47], s79 offen offset:1024 lds
    buffer_load_dwordx4 v20, s[44:47], s79 offen offset:2048 lds
    buffer_load_dwordx4 v21, s[44:47], s79 offen offset:3072 lds
    s_add_u32 m0, s80, 98304
    s_nop 0
    buffer_load_dwordx4 v10, s[40:43], s78 offen offset:0 lds
    buffer_load_dwordx4 v11, s[40:43], s78 offen offset:1024 lds
    buffer_load_dwordx4 v12, s[40:43], s78 offen offset:2048 lds
    buffer_load_dwordx4 v13, s[40:43], s78 offen offset:3072 lds
    s_add_u32 s78, s78, 128
    s_cmp_eq_u32 s78, 1280
    s_cselect_b32 s78, 0, s78
    s_waitcnt vmcnt(20)
    s_barrier
    s_lshl_b32 s79, s78, 12
    s_add_u32 m0, s81, 0
    s_nop 0
    buffer_load_dwordx4 v14, s[44:47], s79 offen offset:0 lds
    buffer_load_dwordx4 v15, s[44:47], s79 offen offset:1024 lds
    buffer_load_dwordx4 v16, s[44:47], s79 offen offset:2048 lds
    buffer_load_dwordx4 v17, s[44:47], s79 offen offset:3072 lds
    s_add_u32 m0, m0, 4096
    s_nop 0
    buffer_load_dwordx4 v18, s[44:47], s79 offen offset:0 lds
    buffer_load_dwordx4 v19, s[44:47], s79 offen offset:1024 lds
    buffer_load_dwordx4 v20, s[44:47], s79 offen offset:2048 lds
    buffer_load_dwordx4 v21, s[44:47], s79 offen offset:3072 lds
    s_add_u32 m0, s80, 0
    s_nop 0
    buffer_load_dwordx4 v10, s[40:43], s78 offen offset:0 lds
    buffer_load_dwordx4 v11, s[40:43], s78 offen offset:1024 lds
    buffer_load_dwordx4 v12, s[40:43], s78 offen offset:2048 lds
    buffer_load_dwordx4 v13, s[40:43], s78 offen offset:3072 lds
    s_add_u32 s78, s78, 128
    s_cmp_eq_u32 s78, 1280
    s_cselect_b32 s78, 0, s78
    s_add_u32 s24, s84, 4096
    buffer_load_dwordx4 v[80:83], v22, s[48:51], s24 offen offset:0 nt
    buffer_load_dwordx4 v[84:87], v23, s[48:51], s24 offen offset:1024 nt
    buffer_load_dwordx4 v[88:91], v24, s[48:51], s24 offen offset:2048 nt
    buffer_load_dwordx4 v[92:95], v25, s[48:51], s24 offen offset:3072 nt
    s_add_u32 s24, s84, 262144
    buffer_load_dwordx4 v[96:99], v22, s[48:51], s24 offen offset:0 nt
    buffer_load_dwordx4 v[100:103], v23, s[48:51], s24 offen offset:1024 nt
    buffer_load_dwordx4 v[104:107], v24, s[48:51], s24 offen offset:2048 nt
    buffer_load_dwordx4 v[108:111], v25, s[48:51], s24 offen offset:3072 nt
    s_waitcnt vmcnt(20)
    s_barrier
    s_lshl_b32 s79, s78, 12
    s_add_u32 m0, s81, 49152
    s_nop 0
    buffer_load_dwordx4 v14, s[44:47], s79 offen offset:0 lds
    buffer_load_dwordx4 v15, s[44:47], s79 offen offset:1024 lds
    buffer_load_dwordx4 v16, s[44:47], s79 offen offset:2048 lds
    buffer_load_dwordx4 v17, s[44:47], s79 offen offset:3072 lds
    s_add_u32 m0, m0, 4096
    s_nop 0
    buffer_load_dwordx4 v18, s[44:47], s79 offen offset:0 lds
    buffer_load_dwordx4 v19, s[44:47], s79 offen offset:1024 lds
    buffer_load_dwordx4 v20, s[44:47], s79 offen offset:2048 lds
    buffer_load_dwordx4 v21, s[44:47], s79 offen offset:3072 lds
    s_add_u32 m0, s80, 49152
    s_nop 0
    buffer_load_dwordx4 v10, s[40:43], s78 offen offset:0 lds
    buffer_load_dwordx4 v11, s[40:43], s78 offen offset:1024 lds
    buffer_load_dwordx4 v12, s[40:43], s78 offen offset:2048 lds
    buffer_load_dwordx4 v13, s[40:43], s78 offen offset:3072 lds
    s_add_u32 s78, s78, 128
    s_cmp_eq_u32 s78, 1280
    s_cselect_b32 s78, 0, s78
    s_waitcnt vmcnt(20)
    s_barrier
    s_lshl_b32 s79, s78, 12
    s_add_u32 m0, s81, 98304
    s_nop 0
    buffer_load_dwordx4 v14, s[44:47], s79 offen offset:0 lds
    buffer_load_dwordx4 v15, s[44:47], s79 offen offset:1024 lds
    buffer_load_dwordx4 v16, s[44:47], s79 offen offset:2048 lds
    buffer_load_dwordx4 v17, s[44:47], s79 offen offset:3072 lds
    s_add_u32 m0, m0, 4096
    s_nop 0
    buffer_load_dwordx4 v18, s[44:47], s79 offen offset:0 lds
    buffer_load_dwordx4 v19, s[44:47], s79 offen offset:1024 lds
    buffer_load_dwordx4 v20, s[44:47], s79 offen offset:2048 lds
    buffer_load_dwordx4 v21, s[44:47], s79 offen offset:3072 lds
    s_add_u32 m0, s80, 98304
    s_nop 0
    buffer_load_dwordx4 v10, s[40:43], s78 offen offset:0 lds
    buffer_load_dwordx4 v11, s[40:43], s78 offen offset:1024 lds
    buffer_load_dwordx4 v12, s[40:43], s78 offen offset:2048 lds
    buffer_load_dwordx4 v13, s[40:43], s78 offen offset:3072 lds
    s_add_u32 s78, s78, 128
    s_cmp_eq_u32 s78, 1280
    s_cselect_b32 s78, 0, s78
    s_add_u32 s24, s7, 0
    s_and_b32 s24, s24, 7
    s_lshl_b32 s24, s24, 13
    buffer_load_dwordx4 v[128:131], v32, s[52:55], s24 offen offset:0
    buffer_load_dwordx4 v[132:135], v33, s[52:55], s24 offen offset:1024
    buffer_load_dwordx4 v[136:139], v34, s[52:55], s24 offen offset:2048
    buffer_load_dwordx4 v[140:143], v35, s[52:55], s24 offen offset:3072
    s_add_u32 s24, s7, 0
    s_and_b32 s24, s24, 7
    s_lshl_b32 s24, s24, 13
    s_add_u32 s24, s24, 128
    buffer_load_dwordx4 v[144:147], v32, s[52:55], s24 offen offset:0
    buffer_load_dwordx4 v[148:151], v33, s[52:55], s24 offen offset:1024
    buffer_load_dwordx4 v[152:155], v34, s[52:55], s24 offen offset:2048
    buffer_load_dwordx4 v[156:159], v35, s[52:55], s24 offen offset:3072
    s_waitcnt vmcnt(20)
    s_barrier
    s_lshl_b32 s79, s78, 12
    s_add_u32 m0, s81, 0
    s_nop 0
    buffer_load_dwordx4 v14, s[44:47], s79 offen offset:0 lds
    buffer_load_dwordx4 v15, s[44:47], s79 offen offset:1024 lds
    buffer_load_dwordx4 v16, s[44:47], s79 offen offset:2048 lds
    buffer_load_dwordx4 v17, s[44:47], s79 offen offset:3072 lds
    s_add_u32 m0, m0, 4096
    s_nop 0
    buffer_load_dwordx4 v18, s[44:47], s79 offen offset:0 lds
    buffer_load_dwordx4 v19, s[44:47], s79 offen offset:1024 lds
    buffer_load_dwordx4 v20, s[44:47], s79 offen offset:2048 lds
    buffer_load_dwordx4 v21, s[44:47], s79 offen offset:3072 lds
    s_add_u32 m0, s80, 0
    s_nop 0
    buffer_load_dwordx4 v10, s[40:43], s78 offen offset:0 lds
    buffer_load_dwordx4 v11, s[40:43], s78 offen offset:1024 lds
    buffer_load_dwordx4 v12, s[40:43], s78 offen offset:2048 lds
    buffer_load_dwordx4 v13, s[40:43], s78 offen offset:3072 lds
    s_add_u32 s78, s78, 128
    s_cmp_eq_u32 s78, 1280
    s_cselect_b32 s78, 0, s78
    s_waitcnt vmcnt(20)
    s_barrier
    s_lshl_b32 s79, s78, 12
    s_add_u32 m0, s81, 49152
    s_nop 0
    buffer_load_dwordx4 v14, s[44:47], s79 offen offset:0 lds
    buffer_load_dwordx4 v15, s[44:47], s79 offen offset:1024 lds
    buffer_load_dwordx4 v16, s[44:47], s79 offen offset:2048 lds
    buffer_load_dwordx4 v17, s[44:47], s79 offen offset:3072 lds
    s_add_u32 m0, m0, 4096
    s_nop 0
    buffer_load_dwordx4 v18, s[44:47], s79 offen offset:0 lds
    buffer_load_dwordx4 v19, s[44:47], s79 offen offset:1024 lds
    buffer_load_dwordx4 v20, s[44:47], s79 offen offset:2048 lds
    buffer_load_dwordx4 v21, s[44:47], s79 offen offset:3072 lds
    s_add_u32 m0, s80, 49152
    s_nop 0
    buffer_load_dwordx4 v10, s[40:43], s78 offen offset:0 lds
    buffer_load_dwordx4 v11, s[40:43], s78 offen offset:1024 lds
    buffer_load_dwordx4 v12, s[40:43], s78 offen offset:2048 lds
    buffer_load_dwordx4 v13, s[40:43], s78 offen offset:3072 lds
    s_waitcnt vmcnt(12)
    s_barrier
L_kjoin:
    s_add_u32 s24, s7, 1
    s_and_b32 s24, s24, 7
    s_lshl_b32 s24, s24, 13
    buffer_load_dwordx4 v[160:163], v32, s[52:55], s24 offen offset:0
    buffer_load_dwordx4 v[164:167], v33, s[52:55], s24 offen offset:1024
    buffer_load_dwordx4 v[168:171], v34, s[52:55], s24 offen offset:2048
    buffer_load_dwordx4 v[172:175], v35, s[52:55], s24 offen offset:3072
    s_add_u32 s24, s7, 1
    s_and_b32 s24, s24, 7
    s_lshl_b32 s24, s24, 13
    s_add_u32 s24, s24, 128
    buffer_load_dwordx4 v[176:179], v32, s[52:55], s24 offen offset:0
    buffer_load_dwordx4 v[180:183], v33, s[52:55], s24 offen offset:1024
    buffer_load_dwordx4 v[184:187], v34, s[52:55], s24 offen offset:2048
    buffer_load_dwordx4 v[188:191], v35, s[52:55], s24 offen offset:3072
    v_add_u32 v3, s85, v38
    ds_write_b128 v3, v[64:67] offset:0
    ds_write_b128 v3, v[68:71] offset:1024
    ds_write_b128 v3, v[72:75] offset:2048
    ds_write_b128 v3, v[76:79] offset:3072
    s_waitcnt vmcnt(8)
    s_barrier
    s_add_u32 s24, s7, 0
    s_and_b32 s24, s24, 7
    s_mul_i32 s24, s24, 163840
    s_add_u32 m0, s4, 0
    s_nop 0
    buffer_load_dwordx4 v26, s[56:59], s24 offen offset:0 lds
    buffer_load_dwordx4 v27, s[56:59], s24 offen offset:1024 lds
    buffer_load_dwordx4 v28, s[56:59], s24 offen offset:2048 lds
    buffer_load_dwordx4 v29, s[56:59], s24 offen offset:3072 lds
    s_add_u32 m0, m0, 4096
    s_nop 0
    buffer_load_dwordx4 v30, s[56:59], s24 offen lds
    v_add_u32 v3, s85, v38
    ds_write_b128 v3, v[80:83] offset:16384
    ds_write_b128 v3, v[84:87] offset:17408
    ds_write_b128 v3, v[88:91] offset:18432
    ds_write_b128 v3, v[92:95] offset:19456
    v_add_u32 v3, s85, v38
    ds_write_b128 v3, v[96:99] offset:32768
    ds_write_b128 v3, v[100:103] offset:33792
    ds_write_b128 v3, v[104:107] offset:34816
    ds_write_b128 v3, v[108:111] offset:35840
    s_waitcnt lgkmcnt(0)
    s_barrier
    s_add_u32 s24, s7, 0
    s_and_b32 s24, s24, 7
    s_mul_i32 s24, s24, 163840
    s_add_u32 s24, s24, 81920
    s_add_u32 m0, s4, 36864
    s_nop 0
    buffer_load_dwordx4 v26, s[56:59], s24 offen offset:0 lds
    buffer_load_dwordx4 v27, s[56:59], s24 offen offset:1024 lds
    buffer_load_dwordx4 v28, s[56:59], s24 offen offset:2048 lds
    buffer_load_dwordx4 v29, s[56:59], s24 offen offset:3072 lds
    s_add_u32 m0, m0, 4096
    s_nop 0
    buffer_load_dwordx4 v30, s[56:59], s24 offen lds
    s_add_u32 s24, s7, 1
    s_and_b32 s24, s24, 7
    s_mul_i32 s24, s24, 163840
    s_add_u32 m0, s4, 73728
    s_nop 0
    buffer_load_dwordx4 v26, s[56:59], s24 offen offset:0 lds
    buffer_load_dwordx4 v27, s[56:59], s24 offen offset:1024 lds
    buffer_load_dwordx4 v28, s[56:59], s24 offen offset:2048 lds
    buffer_load_dwordx4 v29, s[56:59], s24 offen offset:3072 lds
    s_add_u32 m0, m0, 4096
    s_nop 0
    buffer_load_dwordx4 v30, s[56:59], s24 offen lds
    ds_write_b128 v37, v[128:131] offset:0
    ds_write_b128 v37, v[132:135] offset:1024
    ds_write_b128 v37, v[136:139] offset:2048
    ds_write_b128 v37, v[140:143] offset:3072
    v_add_u32 v3, 36864, v37
    ds_write_b128 v3, v[144:147] offset:0
    ds_write_b128 v3, v[148:151] offset:1024
    ds_write_b128 v3, v[152:155] offset:2048
    ds_write_b128 v3, v[156:159] offset:3072
    s_waitcnt lgkmcnt(0)
    s_waitcnt vmcnt(10)
    s_barrier
    v_add_u32 v3, s6, v38
    ds_read_b128 v[44:47], v3 offset:0
    ds_read_b128 v[48:51], v3 offset:1024
    ds_read_b128 v[52:55], v3 offset:8192
    ds_read_b128 v[56:59], v3 offset:9216
    s_lshl_b32 s24, s21, 12
    s_waitcnt lgkmcnt(3)
    buffer_store_dwordx4 v[44:47], v36, s[60:63], s24 offen offset:0 sc1
    s_waitcnt lgkmcnt(2)
    buffer_store_dwordx4 v[48:51], v36, s[60:63], s24 offen offset:1024 sc1
    s_waitcnt lgkmcnt(1)
    buffer_store_dwordx4 v[52:55], v36, s[60:63], s24 offen offset:2048 sc1
    s_waitcnt lgkmcnt(0)
    buffer_store_dwordx4 v[56:59], v36, s[60:63], s24 offen offset:3072 sc1
    s_add_u32 s24, s7, 1
    s_and_b32 s24, s24, 7
    s_mul_i32 s24, s24, 163840
    s_add_u32 s24, s24, 81920
    s_add_u32 m0, s4, 110592
    s_nop 0
    buffer_load_dwordx4 v26, s[56:59], s24 offen offset:0 lds
    buffer_load_dwordx4 v27, s[56:59], s24 offen offset:1024 lds
    buffer_load_dwordx4 v28, s[56:59], s24 offen offset:2048 lds
    buffer_load_dwordx4 v29, s[56:59], s24 offen offset:3072 lds
    s_add_u32 m0, m0, 4096
    s_nop 0
    buffer_load_dwordx4 v30, s[56:59], s24 offen lds
    v_add_u32 v3, 73728, v37
    ds_write_b128 v3, v[160:163] offset:0
    ds_write_b128 v3, v[164:167] offset:1024
    ds_write_b128 v3, v[168:171] offset:2048
    ds_write_b128 v3, v[172:175] offset:3072
    s_waitcnt vmcnt(14)
    s_barrier
    v_add_u32 v3, 110592, v37
    ds_write_b128 v3, v[176:179] offset:0
    ds_write_b128 v3, v[180:183] offset:1024
    ds_write_b128 v3, v[184:187] offset:2048
    ds_write_b128 v3, v[188:191] offset:3072
    v_mov_b32 v4, s27
    v_mov_b32 v5, 0
    s_lshl_b32 s24, s21, 2
    s_add_u32 s24, s24, s87
    s_waitcnt vmcnt(5)
    buffer_store_dword v4, v5, s[72:75], s24 offen sc1
    s_waitcnt lgkmcnt(0)
    s_barrier
    s_add_u32 s24, s7, 2
    s_and_b32 s24, s24, 7
    s_lshl_b32 s24, s24, 13
    s_add_u32 m0, s5, 0
    s_nop 0
    buffer_load_dwordx4 v32, s[52:55], s24 offen offset:0 lds
    buffer_load_dwordx4 v33, s[52:55], s24 offen offset:1024 lds
    buffer_load_dwordx4 v34, s[52:55], s24 offen offset:2048 lds
    buffer_load_dwordx4 v35, s[52:55], s24 offen offset:3072 lds
    s_add_u32 s24, s7, 2
    s_and_b32 s24, s24, 7
    s_mul_i32 s24, s24, 163840
    s_add_u32 m0, s4, 0
    s_nop 0
    buffer_load_dwordx4 v26, s[56:59], s24 offen offset:0 lds
    buffer_load_dwordx4 v27, s[56:59], s24 offen offset:1024 lds
    buffer_load_dwordx4 v28, s[56:59], s24 offen offset:2048 lds
    buffer_load_dwordx4 v29, s[56:59], s24 offen offset:3072 lds
    s_add_u32 m0, m0, 4096
    s_nop 0
    buffer_load_dwordx4 v30, s[56:59], s24 offen lds
    s_waitcnt vmcnt(10)
    s_barrier
    s_add_u32 s24, s7, 2
    s_and_b32 s24, s24, 7
    s_lshl_b32 s24, s24, 13
    s_add_u32 s24, s24, 128
    s_add_u32 m0, s5, 36864
    s_nop 0
    buffer_load_dwordx4 v32, s[52:55], s24 offen offset:0 lds
    buffer_load_dwordx4 v33, s[52:55], s24 offen offset:1024 lds
    buffer_load_dwordx4 v34, s[52:55], s24 offen offset:2048 lds
    buffer_load_dwordx4 v35, s[52:55], s24 offen offset:3072 lds
    s_add_u32 s24, s7, 2
    s_and_b32 s24, s24, 7
    s_mul_i32 s24, s24, 163840
    s_add_u32 s24, s24, 81920
    s_add_u32 m0, s4, 36864
    s_nop 0
    buffer_load_dwordx4 v26, s[56:59], s24 offen offset:0 lds
    buffer_load_dwordx4 v27, s[56:59], s24 offen offset:1024 lds
    buffer_load_dwordx4 v28, s[56:59], s24 offen offset:2048 lds
    buffer_load_dwordx4 v29, s[56:59], s24 offen offset:3072 lds
    s_add_u32 m0, m0, 4096
    s_nop 0
    buffer_load_dwordx4 v30, s[56:59], s24 offen lds
    s_waitcnt vmcnt(9)
    s_barrier
    buffer_load_dword v6, v39, s[72:75], s87 offen sc1
    s_add_u32 s24, s7, 3
    s_and_b32 s24, s24, 7
    s_lshl_b32 s24, s24, 13
    s_add_u32 m0, s5, 73728
    s_nop 0
    buffer_load_dwordx4 v32, s[52:55], s24 offen offset:0 lds
    buffer_load_dwordx4 v33, s[52:55], s24 offen offset:1024 lds
    buffer_load_dwordx4 v34, s[52:55], s24 offen offset:2048 lds
    buffer_load_dwordx4 v35, s[52:55], s24 offen offset:3072 lds
    s_add_u32 s24, s7, 3
    s_and_b32 s24, s24, 7
    s_mul_i32 s24, s24, 163840
    s_add_u32 m0, s4, 73728
    s_nop 0
    buffer_load_dwordx4 v26, s[56:59], s24 offen offset:0 lds
    buffer_load_dwordx4 v27, s[56:59], s24 offen offset:1024 lds
    buffer_load_dwordx4 v28, s[56:59], s24 offen offset:2048 lds
    buffer_load_dwordx4 v29, s[56:59], s24 offen offset:3072 lds
    s_add_u32 m0, m0, 4096
    s_nop 0
    buffer_load_dwordx4 v30, s[56:59], s24 offen lds
    s_mov_b32 s78, 0
    s_add_u32 s24, s21, 1
    s_and_b32 s24, s24, 3
    s_lshl_b32 s24, 0x11111111, s24
    s_or_b32 s78, s78, s24
    s_add_u32 s24, s21, 2
    s_and_b32 s24, s24, 3
    s_lshl_b32 s24, 0x11111111, s24
    s_or_b32 s78, s78, s24
    s_add_u32 s24, s21, 3
    s_and_b32 s24, s24, 3
    s_lshl_b32 s24, 0x11111111, s24
    s_or_b32 s78, s78, s24
    s_not_b32 s78, s78
    s_mov_b32 s79, s78
    s_waitcnt vmcnt(9)
    s_mov_b32 s86, 0
    s_branch L_pspin1_chk
L_pspin1:
    buffer_load_dword v6, v39, s[72:75], s87 offen sc1
    s_waitcnt vmcnt(0)
L_pspin1_chk:
    v_cmp_eq_u32 vcc, s27, v6
    s_add_u32 s86, s86, 1
    s_nop 2
    s_or_b64 vcc, vcc, s[78:79]
    s_cmp_eq_u64 vcc, -1
    s_cbranch_scc1 L_pspin1_ok
    s_cmp_lt_u32 s86, 200000
    s_cbranch_scc1 L_pspin1
L_pspin1_ok:
    s_add_u32 s24, s7, 2
    s_and_b32 s24, s24, 7
    s_lshl_b32 s24, s24, 11
    s_add_u32 m0, s6, 0
    s_nop 0
    buffer_load_dwordx4 v36, s[60:63], s24 offen offset:0 sc1 lds
    buffer_load_dwordx4 v36, s[60:63], s24 offen offset:1024 sc1 lds
    s_barrier
    s_add_u32 s24, s7, 3
    s_and_b32 s24, s24, 7
    s_lshl_b32 s24, s24, 13
    s_add_u32 s24, s24, 128
    s_add_u32 m0, s5, 110592
    s_nop 0
    buffer_load_dwordx4 v32, s[52:55], s24 offen offset:0 lds
    buffer_load_dwordx4 v33, s[52:55], s24 offen offset:1024 lds
    buffer_load_dwordx4 v34, s[52:55], s24 offen offset:2048 lds
    buffer_load_dwordx4 v35, s[52:55], s24 offen offset:3072 lds
    s_add_u32 s24, s7, 3
    s_and_b32 s24, s24, 7
    s_mul_i32 s24, s24, 163840
    s_add_u32 s24, s24, 81920
    s_add_u32 m0, s4, 110592
    s_nop 0
    buffer_load_dwordx4 v26, s[56:59], s24 offen offset:0 lds
    buffer_load_dwordx4 v27, s[56:59], s24 offen offset:1024 lds
    buffer_load_dwordx4 v28, s[56:59], s24 offen offset:2048 lds
    buffer_load_dwordx4 v29, s[56:59], s24 offen offset:3072 lds
    s_add_u32 m0, m0, 4096
    s_nop 0
    buffer_load_dwordx4 v30, s[56:59], s24 offen lds
    s_waitcnt vmcnt(9)
    s_barrier
    s_add_u32 s24, s7, 4
    s_and_b32 s24, s24, 7
    s_lshl_b32 s24, s24, 13
    s_add_u32 m0, s5, 0
    s_nop 0
    buffer_load_dwordx4 v32, s[52:55], s24 offen offset:0 lds
    buffer_load_dwordx4 v33, s[52:55], s24 offen offset:1024 lds
    buffer_load_dwordx4 v34, s[52:55], s24 offen offset:2048 lds
    buffer_load_dwordx4 v35, s[52:55], s24 offen offset:3072 lds
    s_add_u32 s24, s7, 4
    s_and_b32 s24, s24, 7
    s_mul_i32 s24, s24, 163840
    s_add_u32 m0, s4, 0
    s_nop 0
    buffer_load_dwordx4 v26, s[56:59], s24 offen offset:0 lds
    buffer_load_dwordx4 v27, s[56:59], s24 offen offset:1024 lds
    buffer_load_dwordx4 v28, s[56:59], s24 offen offset:2048 lds
    buffer_load_dwordx4 v29, s[56:59], s24 offen offset:3072 lds
    s_add_u32 m0, m0, 4096
    s_nop 0
    buffer_load_dwordx4 v30, s[56:59], s24 offen lds
    s_add_u32 s24, s7, 3
    s_and_b32 s24, s24, 7
    s_lshl_b32 s24, s24, 11
    s_add_u32 m0, s6, 8192
    s_nop 0
    buffer_load_dwordx4 v36, s[60:63], s24 offen offset:0 sc1 lds
    buffer_load_dwordx4 v36, s[60:63], s24 offen offset:1024 sc1 lds
    s_waitcnt vmcnt(11)
    s_barrier
    s_add_u32 s24, s7, 4
    s_and_b32 s24, s24, 7
    s_lshl_b32 s24, s24, 13
    s_add_u32 s24, s24, 128
    s_add_u32 m0, s5, 36864
    s_nop 0
    buffer_load_dwordx4 v32, s[52:55], s24 offen offset:0 lds
    buffer_load_dwordx4 v33, s[52:55], s24 offen offset:1024 lds
    buffer_load_dwordx4 v34, s[52:55], s24 offen offset:2048 lds
    buffer_load_dwordx4 v35, s[52:55], s24 offen offset:3072 lds
    s_add_u32 s24, s7, 4
    s_and_b32 s24, s24, 7
    s_mul_i32 s24, s24, 163840
    s_add_u32 s24, s24, 81920
    s_add_u32 m0, s4, 36864
    s_nop 0
    buffer_load_dwordx4 v26, s[56:59], s24 offen offset:0 lds
    buffer_load_dwordx4 v27, s[56:59], s24 offen offset:1024 lds
    buffer_load_dwordx4 v28, s[56:59], s24 offen offset:2048 lds
    buffer_load_dwordx4 v29, s[56:59], s24 offen offset:3072 lds
    s_add_u32 m0, m0, 4096
    s_nop 0
    buffer_load_dwordx4 v30, s[56:59], s24 offen lds
    s_waitcnt vmcnt(9)
    s_barrier
    s_add_u32 s24, s7, 5
    s_and_b32 s24, s24, 7
    s_lshl_b32 s24, s24, 13
    s_add_u32 m0, s5, 73728
    s_nop 0
    buffer_load_dwordx4 v32, s[52:55], s24 offen offset:0 lds
    buffer_load_dwordx4 v33, s[52:55], s24 offen offset:1024 lds
    buffer_load_dwordx4 v34, s[52:55], s24 offen offset:2048 lds
    buffer_load_dwordx4 v35, s[52:55], s24 offen offset:3072 lds
    s_add_u32 s24, s7, 5
    s_and_b32 s24, s24, 7
    s_mul_i32 s24, s24, 163840
    s_add_u32 m0, s4, 73728
    s_nop 0
    buffer_load_dwordx4 v26, s[56:59], s24 offen offset:0 lds
    buffer_load_dwordx4 v27, s[56:59], s24 offen offset:1024 lds
    buffer_load_dwordx4 v28, s[56:59], s24 offen offset:2048 lds
    buffer_load_dwordx4 v29, s[56:59], s24 offen offset:3072 lds
    s_add_u32 m0, m0, 4096
    s_nop 0
    buffer_load_dwordx4 v30, s[56:59], s24 offen lds
    s_add_u32 s24, s7, 4
    s_and_b32 s24, s24, 7
    s_lshl_b32 s24, s24, 11
    s_add_u32 m0, s6, 0
    s_nop 0
    buffer_load_dwordx4 v36, s[60:63], s24 offen offset:0 sc1 lds
    buffer_load_dwordx4 v36, s[60:63], s24 offen offset:1024 sc1 lds
    s_waitcnt vmcnt(11)
    s_barrier
    s_add_u32 s24, s7, 5
    s_and_b32 s24, s24, 7
    s_lshl_b32 s24, s24, 13
    s_add_u32 s24, s24, 128
    s_add_u32 m0, s5, 110592
    s_nop 0
    buffer_load_dwordx4 v32, s[52:55], s24 offen offset:0 lds
    buffer_load_dwordx4 v33, s[52:55], s24 offen offset:1024 lds
    buffer_load_dwordx4 v34, s[52:55], s24 offen offset:2048 lds
    buffer_load_dwordx4 v35, s[52:55], s24 offen offset:3072 lds
    s_add_u32 s24, s7, 5
    s_and_b32 s24, s24, 7
    s_mul_i32 s24, s24, 163840
    s_add_u32 s24, s24, 81920
    s_add_u32 m0, s4, 110592
    s_nop 0
    buffer_load_dwordx4 v26, s[56:59], s24 offen offset:0 lds
    buffer_load_dwordx4 v27, s[56:59], s24 offen offset:1024 lds
    buffer_load_dwordx4 v28, s[56:59], s24 offen offset:2048 lds
    buffer_load_dwordx4 v29, s[56:59], s24 offen offset:3072 lds
    s_add_u32 m0, m0, 4096
    s_nop 0
    buffer_load_dwordx4 v30, s[56:59], s24 offen lds
    s_waitcnt vmcnt(9)
    s_barrier
    s_add_u32 s24, s7, 6
    s_and_b32 s24, s24, 7
    s_lshl_b32 s24, s24, 13
    s_add_u32 m0, s5, 0
    s_nop 0
    buffer_load_dwordx4 v32, s[52:55], s24 offen offset:0 lds
    buffer_load_dwordx4 v33, s[52:55], s24 offen offset:1024 lds
    buffer_load_dwordx4 v34, s[52:55], s24 offen offset:2048 lds
    buffer_load_dwordx4 v35, s[52:55], s24 offen offset:3072 lds
    s_add_u32 s24, s7, 6
    s_and_b32 s24, s24, 7
    s_mul_i32 s24, s24, 163840
    s_add_u32 m0, s4, 0
    s_nop 0
    buffer_load_dwordx4 v26, s[56:59], s24 offen offset:0 lds
    buffer_load_dwordx4 v27, s[56:59], s24 offen offset:1024 lds
    buffer_load_dwordx4 v28, s[56:59], s24 offen offset:2048 lds
    buffer_load_dwordx4 v29, s[56:59], s24 offen offset:3072 lds
    s_add_u32 m0, m0, 4096
    s_nop 0
    buffer_load_dwordx4 v30, s[56:59], s24 offen lds
    s_add_u32 s24, s7, 5
    s_and_b32 s24, s24, 7
    s_lshl_b32 s24, s24, 11
    s_add_u32 m0, s6, 8192
    s_nop 0
    buffer_load_dwordx4 v36, s[60:63], s24 offen offset:0 sc1 lds
    buffer_load_dwordx4 v36, s[60:63], s24 offen offset:1024 sc1 lds
    s_waitcnt vmcnt(11)
    s_barrier
    s_add_u32 s24, s7, 6
    s_and_b32 s24, s24, 7
    s_lshl_b32 s24, s24, 13
    s_add_u32 s24, s24, 128
    s_add_u32 m0, s5, 36864
    s_nop 0
    buffer_load_dwordx4 v32, s[52:55], s24 offen offset:0 lds
    buffer_load_dwordx4 v33, s[52:55], s24 offen offset:1024 lds
    buffer_load_dwordx4 v34, s[52:55], s24 offen offset:2048 lds
    buffer_load_dwordx4 v35, s[52:55], s24 offen offset:3072 lds
    s_add_u32 s24, s7, 6
    s_and_b32 s24, s24, 7
    s_mul_i32 s24, s24, 163840
    s_add_u32 s24, s24, 81920
    s_add_u32 m0, s4, 36864
    s_nop 0
    buffer_load_dwordx4 v26, s[56:59], s24 offen offset:0 lds
    buffer_load_dwordx4 v27, s[56:59], s24 offen offset:1024 lds
    buffer_load_dwordx4 v28, s[56:59], s24 offen offset:2048 lds
    buffer_load_dwordx4 v29, s[56:59], s24 offen offset:3072 lds
    s_add_u32 m0, m0, 4096
    s_nop 0
    buffer_load_dwordx4 v30, s[56:59], s24 offen lds
    s_waitcnt vmcnt(9)
    s_barrier
    s_add_u32 s24, s7, 7
    s_and_b32 s24, s24, 7
    s_lshl_b32 s24, s24, 13
    s_add_u32 m0, s5, 73728
    s_nop 0
    buffer_load_dwordx4 v32, s[52:55], s24 offen offset:0 lds
    buffer_load_dwordx4 v33, s[52:55], s24 offen offset:1024 lds
    buffer_load_dwordx4 v34, s[52:55], s24 offen offset:2048 lds
    buffer_load_dwordx4 v35, s[52:55], s24 offen offset:3072 lds
    s_add_u32 s24, s7, 7
    s_and_b32 s24, s24, 7
    s_mul_i32 s24, s24, 163840
    s_add_u32 m0, s4, 73728
    s_nop 0
    buffer_load_dwordx4 v26, s[56:59], s24 offen offset:0 lds
    buffer_load_dwordx4 v27, s[56:59], s24 offen offset:1024 lds
    buffer_load_dwordx4 v28, s[56:59], s24 offen offset:2048 lds
    buffer_load_dwordx4 v29, s[56:59], s24 offen offset:3072 lds
    s_add_u32 m0, m0, 4096
    s_nop 0
    buffer_load_dwordx4 v30, s[56:59], s24 offen lds
    s_add_u32 s24, s7, 6
    s_and_b32 s24, s24, 7
    s_lshl_b32 s24, s24, 11
    s_add_u32 m0, s6, 0
    s_nop 0
    buffer_load_dwordx4 v36, s[60:63], s24 offen offset:0 sc1 lds
    buffer_load_dwordx4 v36, s[60:63], s24 offen offset:1024 sc1 lds
    s_waitcnt vmcnt(11)
    s_barrier
    s_add_u32 s24, s7, 7
    s_and_b32 s24, s24, 7
    s_lshl_b32 s24, s24, 13
    s_add_u32 s24, s24, 128
    s_add_u32 m0, s5, 110592
    s_nop 0
    buffer_load_dwordx4 v32, s[52:55], s24 offen offset:0 lds
    buffer_load_dwordx4 v33, s[52:55], s24 offen offset:1024 lds
    buffer_load_dwordx4 v34, s[52:55], s24 offen offset:2048 lds
    buffer_load_dwordx4 v35, s[52:55], s24 offen offset:3072 lds
    s_add_u32 s24, s7, 7
    s_and_b32 s24, s24, 7
    s_mul_i32 s24, s24, 163840
    s_add_u32 s24, s24, 81920
    s_add_u32 m0, s4, 110592
    s_nop 0
    buffer_load_dwordx4 v26, s[56:59], s24 offen offset:0 lds
    buffer_load_dwordx4 v27, s[56:59], s24 offen offset:1024 lds
    buffer_load_dwordx4 v28, s[56:59], s24 offen offset:2048 lds
    buffer_load_dwordx4 v29, s[56:59], s24 offen offset:3072 lds
    s_add_u32 m0, m0, 4096
    s_nop 0
    buffer_load_dwordx4 v30, s[56:59], s24 offen lds
    s_add_u32 s24, s7, 7
    s_and_b32 s24, s24, 7
    s_lshl_b32 s24, s24, 11
    s_add_u32 m0, s6, 8192
    s_nop 0
    buffer_load_dwordx4 v36, s[60:63], s24 offen offset:0 sc1 lds
    buffer_load_dwordx4 v36, s[60:63], s24 offen offset:1024 sc1 lds
    s_waitcnt vmcnt(11)
    s_barrier
    s_waitcnt vmcnt(0)
    s_barrier
    s_lshl_b32 s80, s2, 7
    s_add_u32 s80, s80, 32768
    s_mov_b32 s82, 0x11111111
    s_lshl_b32 s82, s82, s19
    s_mov_b32 s83, s82
    s_mul_i32 s81, s19, 40960
    s_lshl_b32 s84, s39, 11
    s_add_u32 s81, s81, s84
    s_lshl_b32 s79, s39, 5
    s_add_u32 s85, s79, 81920
    s_xor_b32 s84, s19, 1
    s_mul_i32 s84, s84, 10240
    s_add_u32 s76, s81, s84
    s_xor_b32 s84, s19, 2
    s_mul_i32 s84, s84, 10240
    s_add_u32 s77, s81, s84
    s_xor_b32 s84, s19, 3
    s_mul_i32 s84, s84, 10240
    s_add_u32 s78, s81, s84
    v_bfe_u32 v42, v38, 4, 5
    v_mul_u32_u24 v40, 2560, v42
    v_lshrrev_b32 v42, 9, v38
    v_lshl_add_u32 v40, v42, 4, v40
    v_lshrrev_b32 v42, 2, v38
    v_and_b32 v42, 12, v42
    s_lshl_b32 s24, s39, 12
    v_add_u32 v3, s24, v38
    s_barrier
    ds_read_b128 v[48:51], v3 offset:0
    ds_read_b128 v[52:55], v3 offset:1024
    ds_read_b128 v[56:59], v3 offset:2048
    ds_read_b128 v[60:63], v3 offset:3072
    s_mov_b32 s86, 0
L_xspin_l:
    buffer_load_dword v43, v42, s[72:75], s80 offen sc1
    s_waitcnt vmcnt(0)
L_xspin_l_chk:
    v_cmp_eq_u32 vcc, s27, v43
    s_add_u32 s86, s86, 1
    s_nop 2
    s_or_b64 vcc, vcc, s[82:83]
    s_cmp_eq_u64 vcc, -1
    s_cbranch_scc1 L_xspin_l_ok
    s_cmp_lt_u32 s86, 200000
    s_cbranch_scc1 L_xspin_l
L_xspin_l_ok:
    buffer_load_dwordx4 v[64:67], v38, s[64:67], s76 offen offset:0 sc1
    buffer_load_dwordx4 v[68:71], v38, s[64:67], s76 offen offset:1024 sc1
    buffer_load_dwordx4 v[72:75], v38, s[64:67], s77 offen offset:0 sc1
    buffer_load_dwordx4 v[76:79], v38, s[64:67], s77 offen offset:1024 sc1
    buffer_load_dwordx4 v[80:83], v38, s[64:67], s78 offen offset:0 sc1
    buffer_load_dwordx4 v[84:87], v38, s[64:67], s78 offen offset:1024 sc1
    s_mov_b32 s86, 0
    s_waitcnt vmcnt(4)
    v_lshlrev_b32 v44, 16, v64
    v_and_b32 v45, 0xffff0000, v64
    s_waitcnt lgkmcnt(3)
    v_pk_add_f32 v[48:49], v[48:49], v[44:45]
    v_lshlrev_b32 v46, 16, v65
    v_and_b32 v47, 0xffff0000, v65
    v_pk_add_f32 v[50:51], v[50:51], v[46:47]
    v_lshlrev_b32 v44, 16, v66
    v_and_b32 v45, 0xffff0000, v66
    s_waitcnt lgkmcnt(2)
    v_pk_add_f32 v[52:53], v[52:53], v[44:45]
    v_lshlrev_b32 v46, 16, v67
    v_and_b32 v47, 0xffff0000, v67
    v_pk_add_f32 v[54:55], v[54:55], v[46:47]
    v_lshlrev_b32 v44, 16, v68
    v_and_b32 v45, 0xffff0000, v68
    s_waitcnt lgkmcnt(1)
    v_pk_add_f32 v[56:57], v[56:57], v[44:45]
    v_lshlrev_b32 v46, 16, v69
    v_and_b32 v47, 0xffff0000, v69
    v_pk_add_f32 v[58:59], v[58:59], v[46:47]
    v_lshlrev_b32 v44, 16, v70
    v_and_b32 v45, 0xffff0000, v70
    s_waitcnt lgkmcnt(0)
    v_pk_add_f32 v[60:61], v[60:61], v[44:45]
    v_lshlrev_b32 v46, 16, v71
    v_and_b32 v47, 0xffff0000, v71
    v_pk_add_f32 v[62:63], v[62:63], v[46:47]
    s_waitcnt vmcnt(2)
    v_lshlrev_b32 v44, 16, v72
    v_and_b32 v45, 0xffff0000, v72
    v_pk_add_f32 v[48:49], v[48:49], v[44:45]
    v_lshlrev_b32 v46, 16, v73
    v_and_b32 v47, 0xffff0000, v73
    v_pk_add_f32 v[50:51], v[50:51], v[46:47]
    v_lshlrev_b32 v44, 16, v74
    v_and_b32 v45, 0xffff0000, v74
    v_pk_add_f32 v[52:53], v[52:53], v[44:45]
    v_lshlrev_b32 v46, 16, v75
    v_and_b32 v47, 0xffff0000, v75
    v_pk_add_f32 v[54:55], v[54:55], v[46:47]
    v_lshlrev_b32 v44, 16, v76
    v_and_b32 v45, 0xffff0000, v76
    v_pk_add_f32 v[56:57], v[56:57], v[44:45]
    v_lshlrev_b32 v46, 16, v77
    v_and_b32 v47, 0xffff0000, v77
    v_pk_add_f32 v[58:59], v[58:59], v[46:47]
    v_lshlrev_b32 v44, 16, v78
    v_and_b32 v45, 0xffff0000, v78
    v_pk_add_f32 v[60:61], v[60:61], v[44:45]
    v_lshlrev_b32 v46, 16, v79
    v_and_b32 v47, 0xffff0000, v79
    v_pk_add_f32 v[62:63], v[62:63], v[46:47]
    s_waitcnt vmcnt(0)
    v_lshlrev_b32 v44, 16, v80
    v_and_b32 v45, 0xffff0000, v80
    v_pk_add_f32 v[48:49], v[48:49], v[44:45]
    v_lshlrev_b32 v46, 16, v81
    v_and_b32 v47, 0xffff0000, v81
    v_pk_add_f32 v[50:51], v[50:51], v[46:47]
    v_lshlrev_b32 v44, 16, v82
    v_and_b32 v45, 0xffff0000, v82
    v_pk_add_f32 v[52:53], v[52:53], v[44:45]
    v_lshlrev_b32 v46, 16, v83
    v_and_b32 v47, 0xffff0000, v83
    v_pk_add_f32 v[54:55], v[54:55], v[46:47]
    v_lshlrev_b32 v44, 16, v84
    v_and_b32 v45, 0xffff0000, v84
    v_pk_add_f32 v[56:57], v[56:57], v[44:45]
    v_lshlrev_b32 v46, 16, v85
    v_and_b32 v47, 0xffff0000, v85
    v_pk_add_f32 v[58:59], v[58:59], v[46:47]
    v_lshlrev_b32 v44, 16, v86
    v_and_b32 v45, 0xffff0000, v86
    v_pk_add_f32 v[60:61], v[60:61], v[44:45]
    v_lshlrev_b32 v46, 16, v87
    v_and_b32 v47, 0xffff0000, v87
    v_pk_add_f32 v[62:63], v[62:63], v[46:47]
    v_cvt_pk_bf16_f32 v48, v48, v49
    v_cvt_pk_bf16_f32 v49, v50, v51
    v_cvt_pk_bf16_f32 v50, v52, v53
    v_cvt_pk_bf16_f32 v51, v54, v55
    v_cvt_pk_bf16_f32 v52, v56, v57
    v_cvt_pk_bf16_f32 v53, v58, v59
    v_cvt_pk_bf16_f32 v54, v60, v61
    v_cvt_pk_bf16_f32 v55, v62, v63
    v_permlane16_swap_b32 v48, v50
    v_permlane16_swap_b32 v49, v51
    v_permlane16_swap_b32 v52, v54
    v_permlane16_swap_b32 v53, v55
    buffer_store_dwordx4 v[48:51], v40, s[68:71], s79 offen
    buffer_store_dwordx4 v[52:55], v40, s[68:71], s85 offen
L_end:
    s_endpgm
L_compute:
    v_mov_b32 v202, v2
    s_cmp_lt_u32 s23, 4
    s_cbranch_scc0 L_nopf
    s_and_b32 s24, s20, 3
    s_cmp_eq_u32 s24, 0
    s_cbranch_scc0 L_nopf
    s_getpc_b64 s[76:77]
L_pc:
    s_sub_u32 s76, s76, L_pc-concat_heads__gqa_block_cached__gqa_block_cached__near_ridge_kernel
    s_subb_u32 s77, s77, 0
    v_lshlrev_b32 v210, 7, v0
    v_min_u32 v210, L_codeend-concat_heads__gqa_block_cached__gqa_block_cached__near_ridge_kernel-4, v210
    global_load_dword v246, v210, s[76:77]
L_nopf:
    s_and_b32 s77, s23, 1
    s_lshr_b32 s78, s23, 1
    v_bfe_u32 v203, v202, 2, 2
    v_lshrrev_b32 v204, 4, v202
    v_and_b32 v205, 3, v202
    v_and_b32 v206, 15, v202
    v_lshl_add_u32 v207, v204, 3, v203
    v_and_b32 v208, 1, v204
    v_lshl_add_u32 v209, v208, 2, v203
    v_lshlrev_b32 v209, 5, v209
    v_lshl_add_u32 v209, v207, 9, v209
    v_lshl_add_u32 v209, v205, 3, v209
    s_lshl_b32 s24, s77, 8
    s_add_u32 s24, s24, 65536
    v_add_u32 v192, s24, v209
    v_xor_b32 v193, 32, v192
    v_xor_b32 v194, 64, v192
    v_xor_b32 v195, 96, v192
    v_xor_b32 v196, 128, v192
    v_xor_b32 v197, 160, v192
    v_xor_b32 v198, 192, v192
    v_xor_b32 v199, 224, v192
    v_lshrrev_b32 v209, 1, v206
    v_xor_b32 v209, v209, v204
    v_lshlrev_b32 v209, 4, v209
    v_lshl_add_u32 v209, v206, 7, v209
    s_lshl_b32 s24, s78, 13
    s_add_u32 s25, s24, 49152
    v_add_u32 v200, s25, v209
    v_xor_b32 v201, 64, v200
    s_add_u32 s25, s24, 20480
    v_add_u32 v250, s25, v209
    v_xor_b32 v251, 64, v250
    v_lshrrev_b32 v209, 1, v204
    v_xor_b32 v209, v209, v206
    v_lshlrev_b32 v209, 4, v209
    v_lshl_add_u32 v209, v206, 8, v209
    v_lshl_add_u32 v209, v208, 3, v209
    s_lshl_b32 s24, s77, 1
    s_add_u32 s24, s24, s78
    s_lshl_b32 s24, s24, 12
    s_add_u32 s25, s24, 98304
    v_add_u32 v245, s25, v209
    v_lshlrev_b32 v244, 4, v202
    s_add_u32 s25, s24, 147456
    v_add_u32 v247, s25, v244
    s_lshl_b32 s24, s78, 12
    s_add_u32 s24, s24, 147456
    v_add_u32 v252, s24, v244
    v_mul_u32_u24 v209, 320, v207
    v_lshl_add_u32 v209, v205, 3, v209
    s_mul_i32 s24, s77, 160
    v_add_u32 v209, s24, v209
    s_mul_i32 s24, s77, -64
    s_add_u32 s24, s24, 32
    v_mul_lo_u32 v210, s24, v208
    v_add_u32 v248, v209, v210
    v_sub_u32 v249, v209, v210
    v_mov_b32 v0, 0
    v_mov_b32 v1, 0
    v_mov_b32 v2, 0
    v_mov_b32 v3, 0
    v_mov_b32 v4, 0
    v_mov_b32 v5, 0
    v_mov_b32 v6, 0
    v_mov_b32 v7, 0
    v_mov_b32 v8, 0
    v_mov_b32 v9, 0
    v_mov_b32 v10, 0
    v_mov_b32 v11, 0
    v_mov_b32 v12, 0
    v_mov_b32 v13, 0
    v_mov_b32 v14, 0
    v_mov_b32 v15, 0
    v_mov_b32 v16, 0
    v_mov_b32 v17, 0
    v_mov_b32 v18, 0
    v_mov_b32 v19, 0
    v_mov_b32 v20, 0
    v_mov_b32 v21, 0
    v_mov_b32 v22, 0
    v_mov_b32 v23, 0
    v_mov_b32 v24, 0
    v_mov_b32 v25, 0
    v_mov_b32 v26, 0
    v_mov_b32 v27, 0
    v_mov_b32 v28, 0
    v_mov_b32 v29, 0
    v_mov_b32 v30, 0
    v_mov_b32 v31, 0
    v_mov_b32 v32, 0
    v_mov_b32 v33, 0
    v_mov_b32 v34, 0
    v_mov_b32 v35, 0
    v_mov_b32 v36, 0
    v_mov_b32 v37, 0
    v_mov_b32 v38, 0
    v_mov_b32 v39, 0
    v_mov_b32 v40, 0
    v_mov_b32 v41, 0
    v_mov_b32 v42, 0
    v_mov_b32 v43, 0
    v_mov_b32 v44, 0
    v_mov_b32 v45, 0
    v_mov_b32 v46, 0
    v_mov_b32 v47, 0
    v_mov_b32 v48, 0
    v_mov_b32 v49, 0
    v_mov_b32 v50, 0
    v_mov_b32 v51, 0
    v_mov_b32 v52, 0
    v_mov_b32 v53, 0
    v_mov_b32 v54, 0
    v_mov_b32 v55, 0
    v_mov_b32 v56, 0
    v_mov_b32 v57, 0
    v_mov_b32 v58, 0
    v_mov_b32 v59, 0
    v_mov_b32 v60, 0
    v_mov_b32 v61, 0
    v_mov_b32 v62, 0
    v_mov_b32 v63, 0
    v_mov_b32 v64, 0
    v_mov_b32 v65, 0
    v_mov_b32 v66, 0
    v_mov_b32 v67, 0
    v_mov_b32 v68, 0
    v_mov_b32 v69, 0
    v_mov_b32 v70, 0
    v_mov_b32 v71, 0
    v_mov_b32 v72, 0
    v_mov_b32 v73, 0
    v_mov_b32 v74, 0
    v_mov_b32 v75, 0
    v_mov_b32 v76, 0
    v_mov_b32 v77, 0
    v_mov_b32 v78, 0
    v_mov_b32 v79, 0
    v_mov_b32 v80, 0
    v_mov_b32 v81, 0
    v_mov_b32 v82, 0
    v_mov_b32 v83, 0
    v_mov_b32 v84, 0
    v_mov_b32 v85, 0
    v_mov_b32 v86, 0
    v_mov_b32 v87, 0
    v_mov_b32 v88, 0
    v_mov_b32 v89, 0
    v_mov_b32 v90, 0
    v_mov_b32 v91, 0
    v_mov_b32 v92, 0
    v_mov_b32 v93, 0
    v_mov_b32 v94, 0
    v_mov_b32 v95, 0
    v_mov_b32 v96, 0
    v_mov_b32 v97, 0
    v_mov_b32 v98, 0
    v_mov_b32 v99, 0
    v_mov_b32 v100, 0
    v_mov_b32 v101, 0
    v_mov_b32 v102, 0
    v_mov_b32 v103, 0
    v_mov_b32 v104, 0
    v_mov_b32 v105, 0
    v_mov_b32 v106, 0
    v_mov_b32 v107, 0
    v_mov_b32 v108, 0
    v_mov_b32 v109, 0
    v_mov_b32 v110, 0
    v_mov_b32 v111, 0
    v_mov_b32 v112, 0
    v_mov_b32 v113, 0
    v_mov_b32 v114, 0
    v_mov_b32 v115, 0
    v_mov_b32 v116, 0
    v_mov_b32 v117, 0
    v_mov_b32 v118, 0
    v_mov_b32 v119, 0
    v_mov_b32 v120, 0
    v_mov_b32 v121, 0
    v_mov_b32 v122, 0
    v_mov_b32 v123, 0
    v_mov_b32 v124, 0
    v_mov_b32 v125, 0
    v_mov_b32 v126, 0
    v_mov_b32 v127, 0
    s_waitcnt lgkmcnt(0)
    s_and_b32 s24, s2, 0xfc
    s_mul_i32 s24, s24, 40960
    s_add_u32 s24, s24, 4194304
    s_add_u32 s64, s36, s24
    s_addc_u32 s65, s37, 0
    s_sub_u32 s66, 14680064, s24
    s_mov_b32 s67, 0x20000
    s_mov_b32 s24, 16777216
    s_add_u32 s72, s36, s24
    s_addc_u32 s73, s37, 0
    s_sub_u32 s74, 16943104, s24
    s_mov_b32 s75, 0x20000
    s_lshr_b32 s24, s19, 1
    s_lshl_b32 s25, s20, 1
    s_add_u32 s24, s24, s25
    s_mul_i32 s24, s24, 163840
    s_lshl_b32 s25, s18, 2
    s_add_u32 s25, s25, s22
    s_lshl_b32 s25, s25, 1
    s_and_b32 s76, s19, 1
    s_add_u32 s25, s25, s76
    s_mul_i32 s25, s25, 160
    s_add_u32 s24, s24, s25
    s_add_u32 s68, s32, s24
    s_addc_u32 s69, s33, 0
    s_sub_u32 s70, 2621440, s24
    s_mov_b32 s71, 0x20000
    s_lshl_b32 s24, s18, 3
    s_add_u32 s24, s24, s20
    s_lshl_b32 s24, s24, 7
    s_add_u32 s26, s24, 163840
    s_load_dword s27, s[72:73], s26
    s_waitcnt lgkmcnt(0)
    s_mul_i32 s27, s27, 0x9E3779B1
    s_add_u32 s27, s27, 0x7F4A7C15
    v_mov_b32 v253, s27
    v_mov_b32 v254, 0
    s_mov_b32 s28, 0
    s_mov_b32 s30, 1
    s_mov_b32 s31, 49152
    s_mov_b32 s34, 0x3e0293ee
    s_mov_b32 s35, 0x3e0293ee
    s_barrier
    ds_read_b128 v[160:163], v200 offset:0
    ds_read_b64_tr_b16 v[128:129], v192 offset:0
    ds_read_b64_tr_b16 v[130:131], v192 offset:2048
    ds_read_b128 v[164:167], v200 offset:2048
    ds_read_b128 v[168:171], v200 offset:4096
    ds_read_b128 v[172:175], v200 offset:6144
    ds_read_b64_tr_b16 v[132:133], v193 offset:0
    ds_read_b64_tr_b16 v[134:135], v193 offset:2048
    ds_read_b64_tr_b16 v[136:137], v194 offset:0
    ds_read_b64_tr_b16 v[138:139], v194 offset:2048
    ds_read_b64_tr_b16 v[140:141], v195 offset:0
    ds_read_b64_tr_b16 v[142:143], v195 offset:2048
    ds_read_b64_tr_b16 v[144:145], v196 offset:0
    ds_read_b64_tr_b16 v[146:147], v196 offset:2048
    ds_read_b64_tr_b16 v[148:149], v197 offset:0
    ds_read_b64_tr_b16 v[150:151], v197 offset:2048
L_c1:
    s_waitcnt lgkmcnt(7)
    v_mfma_f32_16x16x32_bf16 v[0:3], v[128:131], v[160:163], v[0:3]
    ds_read_b64_tr_b16 v[152:153], v198 offset:0
    v_mfma_f32_16x16x32_bf16 v[8:11], v[128:131], v[164:167], v[8:11]
    ds_read_b64_tr_b16 v[154:155], v198 offset:2048
    v_mfma_f32_16x16x32_bf16 v[16:19], v[128:131], v[168:171], v[16:19]
    ds_read_b64_tr_b16 v[156:157], v199 offset:0
    s_add_u32 s30, s30, 1
    v_mfma_f32_16x16x32_bf16 v[24:27], v[128:131], v[172:175], v[24:27]
    ds_read_b64_tr_b16 v[158:159], v199 offset:2048
    v_mfma_f32_16x16x32_bf16 v[4:7], v[132:135], v[160:163], v[4:7]
    ds_read_b64_tr_b16 v[128:129], v192 offset:16384
    s_cmp_eq_u32 s30, 3
    v_mfma_f32_16x16x32_bf16 v[12:15], v[132:135], v[164:167], v[12:15]
    ds_read_b64_tr_b16 v[130:131], v192 offset:18432
    v_mfma_f32_16x16x32_bf16 v[20:23], v[132:135], v[168:171], v[20:23]
    ds_read_b128 v[176:179], v201 offset:0
    s_cselect_b32 s29, 4294868992, s31
    v_mfma_f32_16x16x32_bf16 v[28:31], v[132:135], v[172:175], v[28:31]
    ds_read_b128 v[180:183], v201 offset:2048
    s_waitcnt lgkmcnt(7)
    v_mfma_f32_16x16x32_bf16 v[32:35], v[136:139], v[160:163], v[32:35]
    ds_read_b128 v[184:187], v201 offset:4096
    s_cselect_b32 s30, 0, s30
    v_mfma_f32_16x16x32_bf16 v[40:43], v[136:139], v[164:167], v[40:43]
    ds_read_b128 v[188:191], v201 offset:6144
    v_mfma_f32_16x16x32_bf16 v[48:51], v[136:139], v[168:171], v[48:51]
    ds_read_b64_tr_b16 v[132:133], v193 offset:16384
    s_add_u32 s28, s28, 1
    v_mfma_f32_16x16x32_bf16 v[56:59], v[136:139], v[172:175], v[56:59]
    ds_read_b64_tr_b16 v[134:135], v193 offset:18432
    v_mfma_f32_16x16x32_bf16 v[36:39], v[140:143], v[160:163], v[36:39]
    ds_read_b64_tr_b16 v[136:137], v194 offset:16384
    v_mfma_f32_16x16x32_bf16 v[44:47], v[140:143], v[164:167], v[44:47]
    ds_read_b64_tr_b16 v[138:139], v194 offset:18432
    v_mfma_f32_16x16x32_bf16 v[52:55], v[140:143], v[168:171], v[52:55]
    v_mfma_f32_16x16x32_bf16 v[60:63], v[140:143], v[172:175], v[60:63]
    ds_read_b64_tr_b16 v[140:141], v195 offset:16384
    v_mfma_f32_16x16x32_bf16 v[64:67], v[144:147], v[160:163], v[64:67]
    ds_read_b64_tr_b16 v[142:143], v195 offset:18432
    v_mfma_f32_16x16x32_bf16 v[72:75], v[144:147], v[164:167], v[72:75]
    v_mfma_f32_16x16x32_bf16 v[80:83], v[144:147], v[168:171], v[80:83]
    v_mfma_f32_16x16x32_bf16 v[88:91], v[144:147], v[172:175], v[88:91]
    ds_read_b64_tr_b16 v[144:145], v196 offset:16384
    v_mfma_f32_16x16x32_bf16 v[68:71], v[148:151], v[160:163], v[68:71]
    ds_read_b64_tr_b16 v[146:147], v196 offset:18432
    v_mfma_f32_16x16x32_bf16 v[76:79], v[148:151], v[164:167], v[76:79]
    v_mfma_f32_16x16x32_bf16 v[84:87], v[148:151], v[168:171], v[84:87]
    v_mfma_f32_16x16x32_bf16 v[92:95], v[148:151], v[172:175], v[92:95]
    ds_read_b64_tr_b16 v[148:149], v197 offset:16384
    s_waitcnt lgkmcnt(7)
    v_mfma_f32_16x16x32_bf16 v[96:99], v[152:155], v[160:163], v[96:99]
    ds_read_b64_tr_b16 v[150:151], v197 offset:18432
    v_mfma_f32_16x16x32_bf16 v[104:107], v[152:155], v[164:167], v[104:107]
    v_mfma_f32_16x16x32_bf16 v[112:115], v[152:155], v[168:171], v[112:115]
    v_mfma_f32_16x16x32_bf16 v[120:123], v[152:155], v[172:175], v[120:123]
    ds_read_b64_tr_b16 v[152:153], v198 offset:16384
    v_mfma_f32_16x16x32_bf16 v[100:103], v[156:159], v[160:163], v[100:103]
    ds_read_b64_tr_b16 v[154:155], v198 offset:18432
    v_mfma_f32_16x16x32_bf16 v[108:111], v[156:159], v[164:167], v[108:111]
    v_mfma_f32_16x16x32_bf16 v[116:119], v[156:159], v[168:171], v[116:119]
    v_mfma_f32_16x16x32_bf16 v[124:127], v[156:159], v[172:175], v[124:127]
    ds_read_b64_tr_b16 v[156:157], v199 offset:16384
    v_mfma_f32_16x16x32_bf16 v[0:3], v[128:131], v[176:179], v[0:3]
    ds_read_b64_tr_b16 v[158:159], v199 offset:18432
    v_mfma_f32_16x16x32_bf16 v[8:11], v[128:131], v[180:183], v[8:11]
    v_add_u32 v192, s29, v192
    v_add_u32 v193, s29, v193
    v_mfma_f32_16x16x32_bf16 v[16:19], v[128:131], v[184:187], v[16:19]
    v_add_u32 v194, s29, v194
    v_add_u32 v195, s29, v195
    v_mfma_f32_16x16x32_bf16 v[24:27], v[128:131], v[188:191], v[24:27]
    v_add_u32 v196, s29, v196
    v_add_u32 v197, s29, v197
    v_mfma_f32_16x16x32_bf16 v[4:7], v[132:135], v[176:179], v[4:7]
    v_add_u32 v198, s29, v198
    v_add_u32 v199, s29, v199
    v_mfma_f32_16x16x32_bf16 v[12:15], v[132:135], v[180:183], v[12:15]
    v_add_u32 v200, s29, v200
    v_add_u32 v201, s29, v201
    v_mfma_f32_16x16x32_bf16 v[20:23], v[132:135], v[184:187], v[20:23]
    v_mfma_f32_16x16x32_bf16 v[28:31], v[132:135], v[188:191], v[28:31]
    s_waitcnt lgkmcnt(7)
    v_mfma_f32_16x16x32_bf16 v[32:35], v[136:139], v[176:179], v[32:35]
    v_mfma_f32_16x16x32_bf16 v[40:43], v[136:139], v[180:183], v[40:43]
    v_mfma_f32_16x16x32_bf16 v[48:51], v[136:139], v[184:187], v[48:51]
    v_mfma_f32_16x16x32_bf16 v[56:59], v[136:139], v[188:191], v[56:59]
    v_mfma_f32_16x16x32_bf16 v[36:39], v[140:143], v[176:179], v[36:39]
    v_mfma_f32_16x16x32_bf16 v[44:47], v[140:143], v[180:183], v[44:47]
    v_mfma_f32_16x16x32_bf16 v[52:55], v[140:143], v[184:187], v[52:55]
    s_cmp_eq_u32 s28, 10
    v_mfma_f32_16x16x32_bf16 v[60:63], v[140:143], v[188:191], v[60:63]
    s_waitcnt lgkmcnt(0)
    s_barrier
    s_cbranch_scc1 L_c1_done
    ds_read_b128 v[160:163], v200 offset:0
    v_mfma_f32_16x16x32_bf16 v[64:67], v[144:147], v[176:179], v[64:67]
    ds_read_b64_tr_b16 v[128:129], v192 offset:0
    v_mfma_f32_16x16x32_bf16 v[72:75], v[144:147], v[180:183], v[72:75]
    ds_read_b64_tr_b16 v[130:131], v192 offset:2048
    v_mfma_f32_16x16x32_bf16 v[80:83], v[144:147], v[184:187], v[80:83]
    ds_read_b128 v[164:167], v200 offset:2048
    v_mfma_f32_16x16x32_bf16 v[88:91], v[144:147], v[188:191], v[88:91]
    ds_read_b128 v[168:171], v200 offset:4096
    v_mfma_f32_16x16x32_bf16 v[68:71], v[148:151], v[176:179], v[68:71]
    ds_read_b128 v[172:175], v200 offset:6144
    v_mfma_f32_16x16x32_bf16 v[76:79], v[148:151], v[180:183], v[76:79]
    ds_read_b64_tr_b16 v[132:133], v193 offset:0
    v_mfma_f32_16x16x32_bf16 v[84:87], v[148:151], v[184:187], v[84:87]
    ds_read_b64_tr_b16 v[134:135], v193 offset:2048
    v_mfma_f32_16x16x32_bf16 v[92:95], v[148:151], v[188:191], v[92:95]
    ds_read_b64_tr_b16 v[136:137], v194 offset:0
    v_mfma_f32_16x16x32_bf16 v[96:99], v[152:155], v[176:179], v[96:99]
    ds_read_b64_tr_b16 v[138:139], v194 offset:2048
    v_mfma_f32_16x16x32_bf16 v[104:107], v[152:155], v[180:183], v[104:107]
    ds_read_b64_tr_b16 v[140:141], v195 offset:0
    v_mfma_f32_16x16x32_bf16 v[112:115], v[152:155], v[184:187], v[112:115]
    ds_read_b64_tr_b16 v[142:143], v195 offset:2048
    v_mfma_f32_16x16x32_bf16 v[120:123], v[152:155], v[188:191], v[120:123]
    ds_read_b64_tr_b16 v[144:145], v196 offset:0
    v_mfma_f32_16x16x32_bf16 v[100:103], v[156:159], v[176:179], v[100:103]
    ds_read_b64_tr_b16 v[146:147], v196 offset:2048
    v_mfma_f32_16x16x32_bf16 v[108:111], v[156:159], v[180:183], v[108:111]
    ds_read_b64_tr_b16 v[148:149], v197 offset:0
    v_mfma_f32_16x16x32_bf16 v[116:119], v[156:159], v[184:187], v[116:119]
    ds_read_b64_tr_b16 v[150:151], v197 offset:2048
    v_mfma_f32_16x16x32_bf16 v[124:127], v[156:159], v[188:191], v[124:127]
    s_branch L_c1
L_c1_done:
    v_xor_b32 v192, 0, v245
    v_xor_b32 v193, 32, v245
    v_xor_b32 v194, 64, v245
    v_xor_b32 v195, 96, v245
    v_mfma_f32_16x16x32_bf16 v[64:67], v[144:147], v[176:179], v[64:67]
    ds_read_b64 v[160:161], v192 offset:0
    v_cvt_pk_bf16_f32 v0, v0, v1
    v_cvt_pk_bf16_f32 v1, v2, v3
    v_mfma_f32_16x16x32_bf16 v[72:75], v[144:147], v[180:183], v[72:75]
    ds_read_b64 v[162:163], v193 offset:0
    v_cvt_pk_bf16_f32 v2, v4, v5
    v_cvt_pk_bf16_f32 v3, v6, v7
    v_mfma_f32_16x16x32_bf16 v[80:83], v[144:147], v[184:187], v[80:83]
    ds_read_b64 v[164:165], v192 offset:16384
    v_cvt_pk_bf16_f32 v8, v8, v9
    v_cvt_pk_bf16_f32 v9, v10, v11
    v_mfma_f32_16x16x32_bf16 v[88:91], v[144:147], v[188:191], v[88:91]
    ds_read_b64 v[166:167], v193 offset:16384
    v_cvt_pk_bf16_f32 v10, v12, v13
    v_cvt_pk_bf16_f32 v11, v14, v15
    v_mfma_f32_16x16x32_bf16 v[68:71], v[148:151], v[176:179], v[68:71]
    ds_read_b64 v[168:169], v192 offset:32768
    v_cvt_pk_bf16_f32 v16, v16, v17
    v_cvt_pk_bf16_f32 v17, v18, v19
    v_mfma_f32_16x16x32_bf16 v[76:79], v[148:151], v[180:183], v[76:79]
    ds_read_b64 v[170:171], v193 offset:32768
    v_cvt_pk_bf16_f32 v18, v20, v21
    v_cvt_pk_bf16_f32 v19, v22, v23
    v_mfma_f32_16x16x32_bf16 v[84:87], v[148:151], v[184:187], v[84:87]
    ds_read_b64 v[172:173], v192 offset:49152
    v_cvt_pk_bf16_f32 v24, v24, v25
    v_cvt_pk_bf16_f32 v25, v26, v27
    v_mfma_f32_16x16x32_bf16 v[92:95], v[148:151], v[188:191], v[92:95]
    ds_read_b64 v[174:175], v193 offset:49152
    v_cvt_pk_bf16_f32 v26, v28, v29
    v_cvt_pk_bf16_f32 v27, v30, v31
    v_mfma_f32_16x16x32_bf16 v[96:99], v[152:155], v[176:179], v[96:99]
    ds_read_b64 v[128:129], v194 offset:0
    v_xor_b32 v196, 128, v245
    v_xor_b32 v197, 160, v245
    v_mfma_f32_16x16x32_bf16 v[104:107], v[152:155], v[180:183], v[104:107]
    ds_read_b64 v[130:131], v195 offset:0
    v_xor_b32 v198, 192, v245
    v_xor_b32 v199, 224, v245
    v_mfma_f32_16x16x32_bf16 v[112:115], v[152:155], v[184:187], v[112:115]
    ds_read_b64 v[132:133], v194 offset:16384
    v_cvt_pk_bf16_f32 v32, v32, v33
    v_cvt_pk_bf16_f32 v33, v34, v35
    v_mfma_f32_16x16x32_bf16 v[120:123], v[152:155], v[188:191], v[120:123]
    ds_read_b64 v[134:135], v195 offset:16384
    v_cvt_pk_bf16_f32 v34, v36, v37
    v_cvt_pk_bf16_f32 v35, v38, v39
    v_mfma_f32_16x16x32_bf16 v[100:103], v[156:159], v[176:179], v[100:103]
    ds_read_b64 v[136:137], v194 offset:32768
    v_cvt_pk_bf16_f32 v40, v40, v41
    v_cvt_pk_bf16_f32 v41, v42, v43
    v_mfma_f32_16x16x32_bf16 v[108:111], v[156:159], v[180:183], v[108:111]
    ds_read_b64 v[138:139], v195 offset:32768
    v_cvt_pk_bf16_f32 v42, v44, v45
    v_cvt_pk_bf16_f32 v43, v46, v47
    v_mfma_f32_16x16x32_bf16 v[116:119], v[156:159], v[184:187], v[116:119]
    ds_read_b64 v[140:141], v194 offset:49152
    v_cvt_pk_bf16_f32 v48, v48, v49
    v_cvt_pk_bf16_f32 v49, v50, v51
    v_mfma_f32_16x16x32_bf16 v[124:127], v[156:159], v[188:191], v[124:127]
    ds_read_b64 v[142:143], v195 offset:49152
    v_cvt_pk_bf16_f32 v50, v52, v53
    v_cvt_pk_bf16_f32 v51, v54, v55
    s_waitcnt lgkmcnt(7)
    v_mfma_f32_16x16x32_bf16 v[212:215], v[160:163], v[0:3], 0
    v_cvt_pk_bf16_f32 v56, v56, v57
    v_cvt_pk_bf16_f32 v57, v58, v59
    v_cvt_pk_bf16_f32 v58, v60, v61
    v_mfma_f32_16x16x32_bf16 v[220:223], v[160:163], v[8:11], 0
    v_cvt_pk_bf16_f32 v59, v62, v63
    ds_read_b64 v[144:145], v196 offset:0
    v_cvt_pk_bf16_f32 v64, v64, v65
    v_mfma_f32_16x16x32_bf16 v[216:219], v[164:167], v[0:3], 0
    ds_read_b64 v[146:147], v197 offset:0
    v_cvt_pk_bf16_f32 v65, v66, v67
    v_cvt_pk_bf16_f32 v66, v68, v69
    v_mfma_f32_16x16x32_bf16 v[224:227], v[164:167], v[8:11], 0
    ds_read_b64 v[148:149], v196 offset:16384
    v_cvt_pk_bf16_f32 v67, v70, v71
    v_cvt_pk_bf16_f32 v72, v72, v73
    v_mfma_f32_16x16x32_bf16 v[228:231], v[168:171], v[16:19], 0
    ds_read_b64 v[150:151], v197 offset:16384
    v_cvt_pk_bf16_f32 v73, v74, v75
    v_cvt_pk_bf16_f32 v74, v76, v77
    v_mfma_f32_16x16x32_bf16 v[236:239], v[168:171], v[24:27], 0
    ds_read_b64 v[152:153], v196 offset:32768
    v_cvt_pk_bf16_f32 v75, v78, v79
    v_cvt_pk_bf16_f32 v80, v80, v81
    v_mfma_f32_16x16x32_bf16 v[232:235], v[172:175], v[16:19], 0
    ds_read_b64 v[154:155], v197 offset:32768
    v_cvt_pk_bf16_f32 v81, v82, v83
    v_cvt_pk_bf16_f32 v82, v84, v85
    v_mfma_f32_16x16x32_bf16 v[240:243], v[172:175], v[24:27], 0
    ds_read_b64 v[156:157], v196 offset:49152
    v_cvt_pk_bf16_f32 v83, v86, v87
    v_cvt_pk_bf16_f32 v88, v88, v89
    s_waitcnt lgkmcnt(7)
    v_mfma_f32_16x16x32_bf16 v[212:215], v[128:131], v[32:35], v[212:215]
    ds_read_b64 v[158:159], v197 offset:49152
    v_cvt_pk_bf16_f32 v89, v90, v91
    v_cvt_pk_bf16_f32 v90, v92, v93
    v_mfma_f32_16x16x32_bf16 v[220:223], v[128:131], v[40:43], v[220:223]
    ds_read_b64 v[176:177], v198 offset:0
    v_cvt_pk_bf16_f32 v91, v94, v95
    v_cvt_pk_bf16_f32 v96, v96, v97
    v_mfma_f32_16x16x32_bf16 v[216:219], v[132:135], v[32:35], v[216:219]
    ds_read_b64 v[178:179], v199 offset:0
    v_cvt_pk_bf16_f32 v97, v98, v99
    v_cvt_pk_bf16_f32 v98, v100, v101
    v_mfma_f32_16x16x32_bf16 v[224:227], v[132:135], v[40:43], v[224:227]
    ds_read_b64 v[180:181], v198 offset:16384
    v_cvt_pk_bf16_f32 v99, v102, v103
    v_cvt_pk_bf16_f32 v104, v104, v105
    v_mfma_f32_16x16x32_bf16 v[228:231], v[136:139], v[48:51], v[228:231]
    ds_read_b64 v[182:183], v199 offset:16384
    v_cvt_pk_bf16_f32 v105, v106, v107
    v_cvt_pk_bf16_f32 v106, v108, v109
    v_mfma_f32_16x16x32_bf16 v[236:239], v[136:139], v[56:59], v[236:239]
    ds_read_b64 v[184:185], v198 offset:32768
    v_cvt_pk_bf16_f32 v107, v110, v111
    v_cvt_pk_bf16_f32 v112, v112, v113
    v_mfma_f32_16x16x32_bf16 v[232:235], v[140:143], v[48:51], v[232:235]
    ds_read_b64 v[186:187], v199 offset:32768
    v_cvt_pk_bf16_f32 v113, v114, v115
    v_cvt_pk_bf16_f32 v114, v116, v117
    v_mfma_f32_16x16x32_bf16 v[240:243], v[140:143], v[56:59], v[240:243]
    ds_read_b64 v[188:189], v198 offset:49152
    v_cvt_pk_bf16_f32 v115, v118, v119
    v_cvt_pk_bf16_f32 v120, v120, v121
    s_waitcnt lgkmcnt(7)
    v_mfma_f32_16x16x32_bf16 v[212:215], v[144:147], v[64:67], v[212:215]
    ds_read_b64 v[190:191], v199 offset:49152
    v_cvt_pk_bf16_f32 v121, v122, v123
    v_cvt_pk_bf16_f32 v122, v124, v125
    v_mfma_f32_16x16x32_bf16 v[220:223], v[144:147], v[72:75], v[220:223]
    v_cvt_pk_bf16_f32 v123, v126, v127
    v_mfma_f32_16x16x32_bf16 v[216:219], v[148:151], v[64:67], v[216:219]
    v_mfma_f32_16x16x32_bf16 v[224:227], v[148:151], v[72:75], v[224:227]
    v_mfma_f32_16x16x32_bf16 v[228:231], v[152:155], v[80:83], v[228:231]
    v_mfma_f32_16x16x32_bf16 v[236:239], v[152:155], v[88:91], v[236:239]
    v_mfma_f32_16x16x32_bf16 v[232:235], v[156:159], v[80:83], v[232:235]
    v_mfma_f32_16x16x32_bf16 v[240:243], v[156:159], v[88:91], v[240:243]
    s_waitcnt lgkmcnt(6)
    v_mfma_f32_16x16x32_bf16 v[212:215], v[176:179], v[96:99], v[212:215]
    v_mfma_f32_16x16x32_bf16 v[220:223], v[176:179], v[104:107], v[220:223]
    s_waitcnt lgkmcnt(4)
    v_mfma_f32_16x16x32_bf16 v[216:219], v[180:183], v[96:99], v[216:219]
    v_mfma_f32_16x16x32_bf16 v[224:227], v[180:183], v[104:107], v[224:227]
    s_waitcnt lgkmcnt(2)
    v_mfma_f32_16x16x32_bf16 v[228:231], v[184:187], v[112:115], v[228:231]
    v_mfma_f32_16x16x32_bf16 v[236:239], v[184:187], v[120:123], v[236:239]
    s_waitcnt lgkmcnt(0)
    v_mfma_f32_16x16x32_bf16 v[232:235], v[188:191], v[112:115], v[232:235]
    v_mfma_f32_16x16x32_bf16 v[240:243], v[188:191], v[120:123], v[240:243]
    v_max3_f32 v192, v212, v213, v214
    v_max3_f32 v193, v220, v221, v222
    s_nop 1
    v_max3_f32 v194, v228, v229, v230
    v_max3_f32 v195, v236, v237, v238
    v_max3_f32 v196, v215, v216, v217
    v_max3_f32 v197, v223, v224, v225
    v_max3_f32 v198, v231, v232, v233
    v_max3_f32 v199, v239, v240, v241
    v_max3_f32 v192, v192, v218, v219
    v_max3_f32 v193, v193, v226, v227
    v_max3_f32 v194, v194, v234, v235
    v_max3_f32 v195, v195, v242, v243
    v_max_f32 v192, v192, v196
    v_max_f32 v193, v193, v197
    v_max_f32 v194, v194, v198
    v_max_f32 v195, v195, v199
    v_permlane32_swap_b32 v192, v193
    s_nop 0
    v_permlane32_swap_b32 v194, v195
    v_max_f32 v192, v192, v193
    v_max_f32 v194, v194, v195
    s_nop 1
    v_permlane16_swap_b32 v192, v194
    v_max_f32 v192, v192, v194
    v_mul_f32 v192, s34, v192
    v_mov_b32 v196, v192
    s_nop 1
    v_permlane16_swap_b32 v192, v196
    v_mov_b32 v194, v192
    v_mov_b32 v198, v196
    s_nop 0
    v_permlane32_swap_b32 v192, v194
    v_permlane32_swap_b32 v196, v198
    v_pk_fma_f32 v[212:213], v[212:213], s[34:35], v[192:193] op_sel_hi:[1,1,0] neg_lo:[0,0,1] neg_hi:[0,0,1]
    v_pk_fma_f32 v[214:215], v[214:215], s[34:35], v[192:193] op_sel_hi:[1,1,0] neg_lo:[0,0,1] neg_hi:[0,0,1]
    v_pk_fma_f32 v[216:217], v[216:217], s[34:35], v[192:193] op_sel_hi:[1,1,0] neg_lo:[0,0,1] neg_hi:[0,0,1]
    v_pk_fma_f32 v[218:219], v[218:219], s[34:35], v[192:193] op_sel_hi:[1,1,0] neg_lo:[0,0,1] neg_hi:[0,0,1]
    v_pk_fma_f32 v[220:221], v[220:221], s[34:35], v[194:195] op_sel_hi:[1,1,0] neg_lo:[0,0,1] neg_hi:[0,0,1]
    v_pk_fma_f32 v[222:223], v[222:223], s[34:35], v[194:195] op_sel_hi:[1,1,0] neg_lo:[0,0,1] neg_hi:[0,0,1]
    v_pk_fma_f32 v[224:225], v[224:225], s[34:35], v[194:195] op_sel_hi:[1,1,0] neg_lo:[0,0,1] neg_hi:[0,0,1]
    v_pk_fma_f32 v[226:227], v[226:227], s[34:35], v[194:195] op_sel_hi:[1,1,0] neg_lo:[0,0,1] neg_hi:[0,0,1]
    v_pk_fma_f32 v[228:229], v[228:229], s[34:35], v[196:197] op_sel_hi:[1,1,0] neg_lo:[0,0,1] neg_hi:[0,0,1]
    v_pk_fma_f32 v[230:231], v[230:231], s[34:35], v[196:197] op_sel_hi:[1,1,0] neg_lo:[0,0,1] neg_hi:[0,0,1]
    v_pk_fma_f32 v[232:233], v[232:233], s[34:35], v[196:197] op_sel_hi:[1,1,0] neg_lo:[0,0,1] neg_hi:[0,0,1]
    v_pk_fma_f32 v[234:235], v[234:235], s[34:35], v[196:197] op_sel_hi:[1,1,0] neg_lo:[0,0,1] neg_hi:[0,0,1]
    v_pk_fma_f32 v[236:237], v[236:237], s[34:35], v[198:199] op_sel_hi:[1,1,0] neg_lo:[0,0,1] neg_hi:[0,0,1]
    v_pk_fma_f32 v[238:239], v[238:239], s[34:35], v[198:199] op_sel_hi:[1,1,0] neg_lo:[0,0,1] neg_hi:[0,0,1]
    v_pk_fma_f32 v[240:241], v[240:241], s[34:35], v[198:199] op_sel_hi:[1,1,0] neg_lo:[0,0,1] neg_hi:[0,0,1]
    v_pk_fma_f32 v[242:243], v[242:243], s[34:35], v[198:199] op_sel_hi:[1,1,0] neg_lo:[0,0,1] neg_hi:[0,0,1]
    v_exp_f32 v212, v212
    v_exp_f32 v213, v213
    v_exp_f32 v214, v214
    v_exp_f32 v215, v215
    v_exp_f32 v216, v216
    v_exp_f32 v217, v217
    v_exp_f32 v218, v218
    v_exp_f32 v219, v219
    v_exp_f32 v220, v220
    v_exp_f32 v221, v221
    v_exp_f32 v222, v222
    v_exp_f32 v223, v223
    v_exp_f32 v224, v224
    v_exp_f32 v225, v225
    v_exp_f32 v226, v226
    v_exp_f32 v227, v227
    v_exp_f32 v228, v228
    v_exp_f32 v229, v229
    v_exp_f32 v230, v230
    v_exp_f32 v231, v231
    v_exp_f32 v232, v232
    v_exp_f32 v233, v233
    v_exp_f32 v234, v234
    v_exp_f32 v235, v235
    v_exp_f32 v236, v236
    v_exp_f32 v237, v237
    v_exp_f32 v238, v238
    v_exp_f32 v239, v239
    v_exp_f32 v240, v240
    v_exp_f32 v241, v241
    v_exp_f32 v242, v242
    v_exp_f32 v243, v243
    v_pk_add_f32 v[160:161], v[212:213], v[214:215]
    v_pk_add_f32 v[162:163], v[216:217], v[218:219]
    v_pk_add_f32 v[164:165], v[220:221], v[222:223]
    v_pk_add_f32 v[166:167], v[224:225], v[226:227]
    v_pk_add_f32 v[168:169], v[228:229], v[230:231]
    v_pk_add_f32 v[170:171], v[232:233], v[234:235]
    v_pk_add_f32 v[172:173], v[236:237], v[238:239]
    v_pk_add_f32 v[174:175], v[240:241], v[242:243]
    v_pk_add_f32 v[160:161], v[160:161], v[162:163]
    v_pk_add_f32 v[164:165], v[164:165], v[166:167]
    v_pk_add_f32 v[168:169], v[168:169], v[170:171]
    v_pk_add_f32 v[172:173], v[172:173], v[174:175]
    v_add_f32 v192, v160, v161
    v_add_f32 v193, v164, v165
    v_add_f32 v194, v168, v169
    v_add_f32 v195, v172, v173
    v_permlane32_swap_b32 v192, v193
    s_nop 0
    v_permlane32_swap_b32 v194, v195
    v_add_f32 v192, v192, v193
    v_add_f32 v194, v194, v195
    s_nop 1
    v_permlane16_swap_b32 v192, v194
    v_add_f32 v192, v192, v194
    v_rcp_f32 v192, v192
    s_nop 0
    v_mov_b32 v196, v192
    s_nop 1
    v_permlane16_swap_b32 v192, v196
    v_mov_b32 v194, v192
    v_mov_b32 v198, v196
    s_nop 0
    v_permlane32_swap_b32 v192, v194
    v_permlane32_swap_b32 v196, v198
    v_pk_mul_f32 v[212:213], v[212:213], v[192:193] op_sel_hi:[1,0]
    v_pk_mul_f32 v[214:215], v[214:215], v[192:193] op_sel_hi:[1,0]
    v_pk_mul_f32 v[216:217], v[216:217], v[192:193] op_sel_hi:[1,0]
    v_pk_mul_f32 v[218:219], v[218:219], v[192:193] op_sel_hi:[1,0]
    v_cvt_pk_bf16_f32 v212, v212, v213
    v_cvt_pk_bf16_f32 v213, v214, v215
    v_cvt_pk_bf16_f32 v214, v216, v217
    v_cvt_pk_bf16_f32 v215, v218, v219
    ds_write_b128 v247, v[212:215] offset:0
    v_pk_mul_f32 v[220:221], v[220:221], v[194:195] op_sel_hi:[1,0]
    v_pk_mul_f32 v[222:223], v[222:223], v[194:195] op_sel_hi:[1,0]
    v_pk_mul_f32 v[224:225], v[224:225], v[194:195] op_sel_hi:[1,0]
    v_pk_mul_f32 v[226:227], v[226:227], v[194:195] op_sel_hi:[1,0]
    v_cvt_pk_bf16_f32 v220, v220, v221
    v_cvt_pk_bf16_f32 v221, v222, v223
    v_cvt_pk_bf16_f32 v222, v224, v225
    v_cvt_pk_bf16_f32 v223, v226, v227
    ds_write_b128 v247, v[220:223] offset:1024
    v_pk_mul_f32 v[228:229], v[228:229], v[196:197] op_sel_hi:[1,0]
    v_pk_mul_f32 v[230:231], v[230:231], v[196:197] op_sel_hi:[1,0]
    v_pk_mul_f32 v[232:233], v[232:233], v[196:197] op_sel_hi:[1,0]
    v_pk_mul_f32 v[234:235], v[234:235], v[196:197] op_sel_hi:[1,0]
    v_cvt_pk_bf16_f32 v228, v228, v229
    v_cvt_pk_bf16_f32 v229, v230, v231
    v_cvt_pk_bf16_f32 v230, v232, v233
    v_cvt_pk_bf16_f32 v231, v234, v235
    ds_write_b128 v247, v[228:231] offset:2048
    v_pk_mul_f32 v[236:237], v[236:237], v[198:199] op_sel_hi:[1,0]
    v_pk_mul_f32 v[238:239], v[238:239], v[198:199] op_sel_hi:[1,0]
    v_pk_mul_f32 v[240:241], v[240:241], v[198:199] op_sel_hi:[1,0]
    v_pk_mul_f32 v[242:243], v[242:243], v[198:199] op_sel_hi:[1,0]
    v_cvt_pk_bf16_f32 v236, v236, v237
    v_cvt_pk_bf16_f32 v237, v238, v239
    v_cvt_pk_bf16_f32 v238, v240, v241
    v_cvt_pk_bf16_f32 v239, v242, v243
    ds_write_b128 v247, v[236:239] offset:3072
    s_mov_b32 s28, 0
    s_mov_b32 s30, 0
    s_mov_b32 s31, 36864
    s_waitcnt lgkmcnt(0)
    s_barrier
    ds_read_b128 v[160:163], v250 offset:0
    ds_read_b64_tr_b16 v[192:193], v248 offset:0
    ds_read_b64_tr_b16 v[194:195], v248 offset:1280
    ds_read_b128 v[164:167], v250 offset:2048
    ds_read_b128 v[168:171], v250 offset:4096
    ds_read_b128 v[172:175], v250 offset:6144
    ds_read_b64_tr_b16 v[196:197], v249 offset:32
    ds_read_b64_tr_b16 v[198:199], v249 offset:1312
    ds_read_b64_tr_b16 v[200:201], v248 offset:64
    ds_read_b64_tr_b16 v[202:203], v248 offset:1344
    ds_read_b64_tr_b16 v[204:205], v249 offset:96
    ds_read_b64_tr_b16 v[206:207], v249 offset:1376
    ds_read_b64_tr_b16 v[208:209], v248 offset:128
    ds_read_b64_tr_b16 v[210:211], v248 offset:1408
    ds_read_b128 v[176:179], v251 offset:0
    ds_read_b128 v[180:183], v251 offset:2048
    ds_read_b128 v[184:187], v251 offset:4096
    ds_read_b128 v[188:191], v251 offset:6144
    s_waitcnt lgkmcnt(7)
    v_mfma_f32_16x16x32_bf16 v[80:83], v[160:163], v[192:195], 0
    v_mfma_f32_16x16x32_bf16 v[84:87], v[164:167], v[192:195], 0
    s_add_u32 s30, s30, 1
    v_mfma_f32_16x16x32_bf16 v[88:91], v[168:171], v[192:195], 0
    v_mfma_f32_16x16x32_bf16 v[92:95], v[172:175], v[192:195], 0
    ds_read_b64_tr_b16 v[192:193], v248 offset:10240
    s_cmp_eq_u32 s30, 4
    v_mfma_f32_16x16x32_bf16 v[96:99], v[160:163], v[196:199], 0
    ds_read_b64_tr_b16 v[194:195], v248 offset:11520
    v_mfma_f32_16x16x32_bf16 v[100:103], v[164:167], v[196:199], 0
    s_cselect_b32 s29, 4294856704, s31
    v_mfma_f32_16x16x32_bf16 v[104:107], v[168:171], v[196:199], 0
    v_mfma_f32_16x16x32_bf16 v[108:111], v[172:175], v[196:199], 0
    ds_read_b64_tr_b16 v[196:197], v249 offset:10272
    s_cselect_b32 s30, 0, s30
    v_mfma_f32_16x16x32_bf16 v[112:115], v[160:163], v[200:203], 0
    ds_read_b64_tr_b16 v[198:199], v249 offset:11552
    v_mfma_f32_16x16x32_bf16 v[116:119], v[164:167], v[200:203], 0
    v_mfma_f32_16x16x32_bf16 v[120:123], v[168:171], v[200:203], 0
    v_mfma_f32_16x16x32_bf16 v[124:127], v[172:175], v[200:203], 0
    ds_read_b64_tr_b16 v[200:201], v248 offset:10304
    s_waitcnt lgkmcnt(7)
    v_mfma_f32_16x16x32_bf16 v[128:131], v[160:163], v[204:207], 0
    ds_read_b64_tr_b16 v[202:203], v248 offset:11584
    v_mfma_f32_16x16x32_bf16 v[132:135], v[164:167], v[204:207], 0
    v_mfma_f32_16x16x32_bf16 v[136:139], v[168:171], v[204:207], 0
    v_mfma_f32_16x16x32_bf16 v[140:143], v[172:175], v[204:207], 0
    ds_read_b64_tr_b16 v[204:205], v249 offset:10336
    v_mfma_f32_16x16x32_bf16 v[144:147], v[160:163], v[208:211], 0
    ds_read_b64_tr_b16 v[206:207], v249 offset:11616
    v_mfma_f32_16x16x32_bf16 v[148:151], v[164:167], v[208:211], 0
    v_mfma_f32_16x16x32_bf16 v[152:155], v[168:171], v[208:211], 0
    v_mfma_f32_16x16x32_bf16 v[156:159], v[172:175], v[208:211], 0
    ds_read_b64_tr_b16 v[208:209], v248 offset:10368
    s_waitcnt lgkmcnt(7)
    v_mfma_f32_16x16x32_bf16 v[80:83], v[176:179], v[192:195], v[80:83]
    ds_read_b64_tr_b16 v[210:211], v248 offset:11648
    v_mfma_f32_16x16x32_bf16 v[84:87], v[180:183], v[192:195], v[84:87]
    v_add_u32 v248, s29, v248
    v_add_u32 v249, s29, v249
    v_mfma_f32_16x16x32_bf16 v[88:91], v[184:187], v[192:195], v[88:91]
    v_add_u32 v250, s29, v250
    v_add_u32 v251, s29, v251
    v_mfma_f32_16x16x32_bf16 v[92:95], v[188:191], v[192:195], v[92:95]
    s_waitcnt lgkmcnt(6)
    v_mfma_f32_16x16x32_bf16 v[96:99], v[176:179], v[196:199], v[96:99]
    v_mfma_f32_16x16x32_bf16 v[100:103], v[180:183], v[196:199], v[100:103]
    v_mfma_f32_16x16x32_bf16 v[104:107], v[184:187], v[196:199], v[104:107]
    v_mfma_f32_16x16x32_bf16 v[108:111], v[188:191], v[196:199], v[108:111]
    s_waitcnt lgkmcnt(0)
    s_barrier
    v_mfma_f32_16x16x32_bf16 v[112:115], v[176:179], v[200:203], v[112:115]
    ds_read_b128 v[160:163], v250 offset:0
    v_mfma_f32_16x16x32_bf16 v[116:119], v[180:183], v[200:203], v[116:119]
    ds_read_b64_tr_b16 v[192:193], v248 offset:0
    s_add_u32 s30, s30, 1
    v_mfma_f32_16x16x32_bf16 v[120:123], v[184:187], v[200:203], v[120:123]
    ds_read_b64_tr_b16 v[194:195], v248 offset:1280
    v_mfma_f32_16x16x32_bf16 v[124:127], v[188:191], v[200:203], v[124:127]
    ds_read_b128 v[164:167], v250 offset:2048
    s_cmp_eq_u32 s30, 4
    v_mfma_f32_16x16x32_bf16 v[128:131], v[176:179], v[204:207], v[128:131]
    ds_read_b128 v[168:171], v250 offset:4096
    v_mfma_f32_16x16x32_bf16 v[132:135], v[180:183], v[204:207], v[132:135]
    ds_read_b128 v[172:175], v250 offset:6144
    s_cselect_b32 s29, 4294856704, s31
    v_mfma_f32_16x16x32_bf16 v[136:139], v[184:187], v[204:207], v[136:139]
    ds_read_b64_tr_b16 v[196:197], v249 offset:32
    v_mfma_f32_16x16x32_bf16 v[140:143], v[188:191], v[204:207], v[140:143]
    ds_read_b64_tr_b16 v[198:199], v249 offset:1312
    s_cselect_b32 s30, 0, s30
    v_mfma_f32_16x16x32_bf16 v[144:147], v[176:179], v[208:211], v[144:147]
    ds_read_b64_tr_b16 v[200:201], v248 offset:64
    v_mfma_f32_16x16x32_bf16 v[148:151], v[180:183], v[208:211], v[148:151]
    ds_read_b64_tr_b16 v[202:203], v248 offset:1344
    v_mfma_f32_16x16x32_bf16 v[152:155], v[184:187], v[208:211], v[152:155]
    ds_read_b64_tr_b16 v[204:205], v249 offset:96
    v_mfma_f32_16x16x32_bf16 v[156:159], v[188:191], v[208:211], v[156:159]
    ds_read_b64_tr_b16 v[206:207], v249 offset:1376
    s_waitcnt lgkmcnt(9)
    v_mfma_f32_16x16x32_bf16 v[80:83], v[160:163], v[192:195], v[80:83]
    ds_read_b64_tr_b16 v[208:209], v248 offset:128
    s_waitcnt lgkmcnt(9)
    v_mfma_f32_16x16x32_bf16 v[84:87], v[164:167], v[192:195], v[84:87]
    ds_read_b64_tr_b16 v[210:211], v248 offset:1408
    s_waitcnt lgkmcnt(9)
    v_mfma_f32_16x16x32_bf16 v[88:91], v[168:171], v[192:195], v[88:91]
    ds_read_b128 v[176:179], v251 offset:0
    s_waitcnt lgkmcnt(9)
    v_mfma_f32_16x16x32_bf16 v[92:95], v[172:175], v[192:195], v[92:95]
    ds_read_b128 v[180:183], v251 offset:2048
    s_waitcnt lgkmcnt(8)
    v_mfma_f32_16x16x32_bf16 v[96:99], v[160:163], v[196:199], v[96:99]
    ds_read_b128 v[184:187], v251 offset:4096
    v_mfma_f32_16x16x32_bf16 v[100:103], v[164:167], v[196:199], v[100:103]
    ds_read_b128 v[188:191], v251 offset:6144
    v_mfma_f32_16x16x32_bf16 v[104:107], v[168:171], v[196:199], v[104:107]
    ds_read_b64_tr_b16 v[192:193], v248 offset:10240
    v_mfma_f32_16x16x32_bf16 v[108:111], v[172:175], v[196:199], v[108:111]
    ds_read_b64_tr_b16 v[194:195], v248 offset:11520
    s_waitcnt lgkmcnt(7)
    v_mfma_f32_16x16x32_bf16 v[112:115], v[160:163], v[200:203], v[112:115]
    ds_read_b64_tr_b16 v[196:197], v249 offset:10272
    v_mfma_f32_16x16x32_bf16 v[116:119], v[164:167], v[200:203], v[116:119]
    ds_read_b64_tr_b16 v[198:199], v249 offset:11552
    v_mfma_f32_16x16x32_bf16 v[120:123], v[168:171], v[200:203], v[120:123]
    v_mfma_f32_16x16x32_bf16 v[124:127], v[172:175], v[200:203], v[124:127]
    ds_read_b64_tr_b16 v[200:201], v248 offset:10304
    v_mfma_f32_16x16x32_bf16 v[128:131], v[160:163], v[204:207], v[128:131]
    ds_read_b64_tr_b16 v[202:203], v248 offset:11584
    v_mfma_f32_16x16x32_bf16 v[132:135], v[164:167], v[204:207], v[132:135]
    v_mfma_f32_16x16x32_bf16 v[136:139], v[168:171], v[204:207], v[136:139]
    v_mfma_f32_16x16x32_bf16 v[140:143], v[172:175], v[204:207], v[140:143]
    ds_read_b64_tr_b16 v[204:205], v249 offset:10336
    s_waitcnt lgkmcnt(7)
    v_mfma_f32_16x16x32_bf16 v[144:147], v[160:163], v[208:211], v[144:147]
    ds_read_b64_tr_b16 v[206:207], v249 offset:11616
    v_mfma_f32_16x16x32_bf16 v[148:151], v[164:167], v[208:211], v[148:151]
    v_mfma_f32_16x16x32_bf16 v[152:155], v[168:171], v[208:211], v[152:155]
    v_mfma_f32_16x16x32_bf16 v[156:159], v[172:175], v[208:211], v[156:159]
    ds_read_b64_tr_b16 v[208:209], v248 offset:10368
    s_waitcnt lgkmcnt(7)
    v_mfma_f32_16x16x32_bf16 v[80:83], v[176:179], v[192:195], v[80:83]
    ds_read_b64_tr_b16 v[210:211], v248 offset:11648
    v_mfma_f32_16x16x32_bf16 v[84:87], v[180:183], v[192:195], v[84:87]
    v_add_u32 v248, s29, v248
    v_add_u32 v249, s29, v249
    v_mfma_f32_16x16x32_bf16 v[88:91], v[184:187], v[192:195], v[88:91]
    v_add_u32 v250, s29, v250
    v_add_u32 v251, s29, v251
    v_mfma_f32_16x16x32_bf16 v[92:95], v[188:191], v[192:195], v[92:95]
    s_waitcnt lgkmcnt(6)
    v_mfma_f32_16x16x32_bf16 v[96:99], v[176:179], v[196:199], v[96:99]
    v_cvt_pk_bf16_f32 v80, v80, v81
    v_cvt_pk_bf16_f32 v81, v82, v83
    v_mfma_f32_16x16x32_bf16 v[100:103], v[180:183], v[196:199], v[100:103]
    v_cvt_pk_bf16_f32 v82, v84, v85
    v_cvt_pk_bf16_f32 v83, v86, v87
    v_mfma_f32_16x16x32_bf16 v[104:107], v[184:187], v[196:199], v[104:107]
    v_cvt_pk_bf16_f32 v88, v88, v89
    v_cvt_pk_bf16_f32 v89, v90, v91
    v_mfma_f32_16x16x32_bf16 v[108:111], v[188:191], v[196:199], v[108:111]
    s_waitcnt lgkmcnt(0)
    s_barrier
    v_mfma_f32_16x16x32_bf16 v[112:115], v[176:179], v[200:203], v[112:115]
    ds_read_b128 v[212:215], v252 offset:0
    v_cvt_pk_bf16_f32 v90, v92, v93
    v_mfma_f32_16x16x32_bf16 v[116:119], v[180:183], v[200:203], v[116:119]
    ds_read_b128 v[216:219], v252 offset:1024
    v_cvt_pk_bf16_f32 v91, v94, v95
    v_mfma_f32_16x16x32_bf16 v[120:123], v[184:187], v[200:203], v[120:123]
    ds_read_b128 v[220:223], v252 offset:2048
    v_cvt_pk_bf16_f32 v96, v96, v97
    v_mfma_f32_16x16x32_bf16 v[124:127], v[188:191], v[200:203], v[124:127]
    ds_read_b128 v[224:227], v252 offset:3072
    v_cvt_pk_bf16_f32 v97, v98, v99
    v_mfma_f32_16x16x32_bf16 v[128:131], v[176:179], v[204:207], v[128:131]
    ds_read_b128 v[160:163], v250 offset:0
    v_cvt_pk_bf16_f32 v98, v100, v101
    v_mfma_f32_16x16x32_bf16 v[132:135], v[180:183], v[204:207], v[132:135]
    ds_read_b64_tr_b16 v[192:193], v248 offset:0
    v_cvt_pk_bf16_f32 v99, v102, v103
    v_mfma_f32_16x16x32_bf16 v[136:139], v[184:187], v[204:207], v[136:139]
    ds_read_b64_tr_b16 v[194:195], v248 offset:1280
    v_cvt_pk_bf16_f32 v104, v104, v105
    v_mfma_f32_16x16x32_bf16 v[140:143], v[188:191], v[204:207], v[140:143]
    ds_read_b128 v[164:167], v250 offset:2048
    v_cvt_pk_bf16_f32 v105, v106, v107
    v_mfma_f32_16x16x32_bf16 v[144:147], v[176:179], v[208:211], v[144:147]
    ds_read_b128 v[168:171], v250 offset:4096
    v_cvt_pk_bf16_f32 v106, v108, v109
    v_mfma_f32_16x16x32_bf16 v[148:151], v[180:183], v[208:211], v[148:151]
    ds_read_b128 v[172:175], v250 offset:6144
    v_cvt_pk_bf16_f32 v107, v110, v111
    v_mfma_f32_16x16x32_bf16 v[152:155], v[184:187], v[208:211], v[152:155]
    ds_read_b64_tr_b16 v[196:197], v249 offset:32
    v_xor_b32 v252, 8192, v252
    v_mfma_f32_16x16x32_bf16 v[156:159], v[188:191], v[208:211], v[156:159]
    ds_read_b64_tr_b16 v[198:199], v249 offset:1312
    v_cvt_pk_bf16_f32 v112, v112, v113
    s_waitcnt lgkmcnt(7)
    v_mfma_f32_16x16x32_bf16 v[0:3], v[80:83], v[212:215], 0
    ds_read_b64_tr_b16 v[200:201], v248 offset:64
    v_cvt_pk_bf16_f32 v113, v114, v115
    v_mfma_f32_16x16x32_bf16 v[4:7], v[80:83], v[216:219], 0
    ds_read_b64_tr_b16 v[202:203], v248 offset:1344
    v_cvt_pk_bf16_f32 v114, v116, v117
    v_mfma_f32_16x16x32_bf16 v[8:11], v[88:91], v[220:223], 0
    ds_read_b64_tr_b16 v[204:205], v249 offset:96
    v_cvt_pk_bf16_f32 v115, v118, v119
    v_mfma_f32_16x16x32_bf16 v[12:15], v[88:91], v[224:227], 0
    ds_read_b64_tr_b16 v[206:207], v249 offset:1376
    v_cvt_pk_bf16_f32 v120, v120, v121
    v_mfma_f32_16x16x32_bf16 v[16:19], v[96:99], v[212:215], 0
    ds_read_b64_tr_b16 v[208:209], v248 offset:128
    v_cvt_pk_bf16_f32 v121, v122, v123
    v_mfma_f32_16x16x32_bf16 v[20:23], v[96:99], v[216:219], 0
    ds_read_b64_tr_b16 v[210:211], v248 offset:1408
    v_cvt_pk_bf16_f32 v122, v124, v125
    v_mfma_f32_16x16x32_bf16 v[24:27], v[104:107], v[220:223], 0
    ds_read_b128 v[176:179], v251 offset:0
    v_cvt_pk_bf16_f32 v123, v126, v127
    v_mfma_f32_16x16x32_bf16 v[28:31], v[104:107], v[224:227], 0
    ds_read_b128 v[180:183], v251 offset:2048
    v_cvt_pk_bf16_f32 v128, v128, v129
    v_mfma_f32_16x16x32_bf16 v[32:35], v[112:115], v[212:215], 0
    ds_read_b128 v[184:187], v251 offset:4096
    v_cvt_pk_bf16_f32 v129, v130, v131
    v_mfma_f32_16x16x32_bf16 v[36:39], v[112:115], v[216:219], 0
    ds_read_b128 v[188:191], v251 offset:6144
    v_cvt_pk_bf16_f32 v130, v132, v133
    v_mfma_f32_16x16x32_bf16 v[40:43], v[120:123], v[220:223], 0
    v_cvt_pk_bf16_f32 v131, v134, v135
    v_cvt_pk_bf16_f32 v136, v136, v137
    v_mfma_f32_16x16x32_bf16 v[44:47], v[120:123], v[224:227], 0
    v_cvt_pk_bf16_f32 v137, v138, v139
    v_cvt_pk_bf16_f32 v138, v140, v141
    v_mfma_f32_16x16x32_bf16 v[48:51], v[128:131], v[212:215], 0
    v_cvt_pk_bf16_f32 v139, v142, v143
    v_cvt_pk_bf16_f32 v144, v144, v145
    v_mfma_f32_16x16x32_bf16 v[52:55], v[128:131], v[216:219], 0
    v_cvt_pk_bf16_f32 v145, v146, v147
    v_cvt_pk_bf16_f32 v146, v148, v149
    v_mfma_f32_16x16x32_bf16 v[56:59], v[136:139], v[220:223], 0
    v_cvt_pk_bf16_f32 v147, v150, v151
    v_cvt_pk_bf16_f32 v152, v152, v153
    v_mfma_f32_16x16x32_bf16 v[60:63], v[136:139], v[224:227], 0
    v_cvt_pk_bf16_f32 v153, v154, v155
    v_cvt_pk_bf16_f32 v154, v156, v157
    v_mfma_f32_16x16x32_bf16 v[64:67], v[144:147], v[212:215], 0
    v_cvt_pk_bf16_f32 v155, v158, v159
    v_mfma_f32_16x16x32_bf16 v[68:71], v[144:147], v[216:219], 0
    s_nop 0
    v_mfma_f32_16x16x32_bf16 v[72:75], v[152:155], v[220:223], 0
    v_mfma_f32_16x16x32_bf16 v[76:79], v[152:155], v[224:227], 0
L_c2:
    s_waitcnt lgkmcnt(7)
    v_mfma_f32_16x16x32_bf16 v[80:83], v[160:163], v[192:195], 0
    v_mfma_f32_16x16x32_bf16 v[84:87], v[164:167], v[192:195], 0
    s_add_u32 s30, s30, 1
    v_mfma_f32_16x16x32_bf16 v[88:91], v[168:171], v[192:195], 0
    v_mfma_f32_16x16x32_bf16 v[92:95], v[172:175], v[192:195], 0
    ds_read_b64_tr_b16 v[192:193], v248 offset:10240
    s_cmp_eq_u32 s30, 4
    v_mfma_f32_16x16x32_bf16 v[96:99], v[160:163], v[196:199], 0
    ds_read_b64_tr_b16 v[194:195], v248 offset:11520
    v_mfma_f32_16x16x32_bf16 v[100:103], v[164:167], v[196:199], 0
    s_cselect_b32 s29, 4294856704, s31
    v_mfma_f32_16x16x32_bf16 v[104:107], v[168:171], v[196:199], 0
    v_mfma_f32_16x16x32_bf16 v[108:111], v[172:175], v[196:199], 0
    ds_read_b64_tr_b16 v[196:197], v249 offset:10272
    s_cselect_b32 s30, 0, s30
    v_mfma_f32_16x16x32_bf16 v[112:115], v[160:163], v[200:203], 0
    ds_read_b64_tr_b16 v[198:199], v249 offset:11552
    v_mfma_f32_16x16x32_bf16 v[116:119], v[164:167], v[200:203], 0
    v_mfma_f32_16x16x32_bf16 v[120:123], v[168:171], v[200:203], 0
    v_mfma_f32_16x16x32_bf16 v[124:127], v[172:175], v[200:203], 0
    ds_read_b64_tr_b16 v[200:201], v248 offset:10304
    s_waitcnt lgkmcnt(7)
    v_mfma_f32_16x16x32_bf16 v[128:131], v[160:163], v[204:207], 0
    ds_read_b64_tr_b16 v[202:203], v248 offset:11584
    v_mfma_f32_16x16x32_bf16 v[132:135], v[164:167], v[204:207], 0
    v_mfma_f32_16x16x32_bf16 v[136:139], v[168:171], v[204:207], 0
    v_mfma_f32_16x16x32_bf16 v[140:143], v[172:175], v[204:207], 0
    ds_read_b64_tr_b16 v[204:205], v249 offset:10336
    v_mfma_f32_16x16x32_bf16 v[144:147], v[160:163], v[208:211], 0
    ds_read_b64_tr_b16 v[206:207], v249 offset:11616
    v_mfma_f32_16x16x32_bf16 v[148:151], v[164:167], v[208:211], 0
    v_mfma_f32_16x16x32_bf16 v[152:155], v[168:171], v[208:211], 0
    v_mfma_f32_16x16x32_bf16 v[156:159], v[172:175], v[208:211], 0
    ds_read_b64_tr_b16 v[208:209], v248 offset:10368
    s_waitcnt lgkmcnt(7)
    v_mfma_f32_16x16x32_bf16 v[80:83], v[176:179], v[192:195], v[80:83]
    ds_read_b64_tr_b16 v[210:211], v248 offset:11648
    v_mfma_f32_16x16x32_bf16 v[84:87], v[180:183], v[192:195], v[84:87]
    v_add_u32 v248, s29, v248
    v_add_u32 v249, s29, v249
    v_mfma_f32_16x16x32_bf16 v[88:91], v[184:187], v[192:195], v[88:91]
    v_add_u32 v250, s29, v250
    v_add_u32 v251, s29, v251
    v_mfma_f32_16x16x32_bf16 v[92:95], v[188:191], v[192:195], v[92:95]
    s_waitcnt lgkmcnt(6)
    v_mfma_f32_16x16x32_bf16 v[96:99], v[176:179], v[196:199], v[96:99]
    v_mfma_f32_16x16x32_bf16 v[100:103], v[180:183], v[196:199], v[100:103]
    v_mfma_f32_16x16x32_bf16 v[104:107], v[184:187], v[196:199], v[104:107]
    v_mfma_f32_16x16x32_bf16 v[108:111], v[188:191], v[196:199], v[108:111]
    s_waitcnt lgkmcnt(0)
    s_barrier
    v_mfma_f32_16x16x32_bf16 v[112:115], v[176:179], v[200:203], v[112:115]
    ds_read_b128 v[160:163], v250 offset:0
    v_mfma_f32_16x16x32_bf16 v[116:119], v[180:183], v[200:203], v[116:119]
    ds_read_b64_tr_b16 v[192:193], v248 offset:0
    s_add_u32 s30, s30, 1
    v_mfma_f32_16x16x32_bf16 v[120:123], v[184:187], v[200:203], v[120:123]
    ds_read_b64_tr_b16 v[194:195], v248 offset:1280
    v_mfma_f32_16x16x32_bf16 v[124:127], v[188:191], v[200:203], v[124:127]
    ds_read_b128 v[164:167], v250 offset:2048
    s_cmp_eq_u32 s30, 4
    v_mfma_f32_16x16x32_bf16 v[128:131], v[176:179], v[204:207], v[128:131]
    ds_read_b128 v[168:171], v250 offset:4096
    v_mfma_f32_16x16x32_bf16 v[132:135], v[180:183], v[204:207], v[132:135]
    ds_read_b128 v[172:175], v250 offset:6144
    s_cselect_b32 s29, 4294856704, s31
    v_mfma_f32_16x16x32_bf16 v[136:139], v[184:187], v[204:207], v[136:139]
    ds_read_b64_tr_b16 v[196:197], v249 offset:32
    v_mfma_f32_16x16x32_bf16 v[140:143], v[188:191], v[204:207], v[140:143]
    ds_read_b64_tr_b16 v[198:199], v249 offset:1312
    s_cselect_b32 s30, 0, s30
    v_mfma_f32_16x16x32_bf16 v[144:147], v[176:179], v[208:211], v[144:147]
    ds_read_b64_tr_b16 v[200:201], v248 offset:64
    v_mfma_f32_16x16x32_bf16 v[148:151], v[180:183], v[208:211], v[148:151]
    ds_read_b64_tr_b16 v[202:203], v248 offset:1344
    v_mfma_f32_16x16x32_bf16 v[152:155], v[184:187], v[208:211], v[152:155]
    ds_read_b64_tr_b16 v[204:205], v249 offset:96
    v_mfma_f32_16x16x32_bf16 v[156:159], v[188:191], v[208:211], v[156:159]
    ds_read_b64_tr_b16 v[206:207], v249 offset:1376
    s_waitcnt lgkmcnt(9)
    v_mfma_f32_16x16x32_bf16 v[80:83], v[160:163], v[192:195], v[80:83]
    ds_read_b64_tr_b16 v[208:209], v248 offset:128
    s_waitcnt lgkmcnt(9)
    v_mfma_f32_16x16x32_bf16 v[84:87], v[164:167], v[192:195], v[84:87]
    ds_read_b64_tr_b16 v[210:211], v248 offset:1408
    s_waitcnt lgkmcnt(9)
    v_mfma_f32_16x16x32_bf16 v[88:91], v[168:171], v[192:195], v[88:91]
    ds_read_b128 v[176:179], v251 offset:0
    s_waitcnt lgkmcnt(9)
    v_mfma_f32_16x16x32_bf16 v[92:95], v[172:175], v[192:195], v[92:95]
    ds_read_b128 v[180:183], v251 offset:2048
    s_waitcnt lgkmcnt(8)
    v_mfma_f32_16x16x32_bf16 v[96:99], v[160:163], v[196:199], v[96:99]
    ds_read_b128 v[184:187], v251 offset:4096
    v_mfma_f32_16x16x32_bf16 v[100:103], v[164:167], v[196:199], v[100:103]
    ds_read_b128 v[188:191], v251 offset:6144
    v_mfma_f32_16x16x32_bf16 v[104:107], v[168:171], v[196:199], v[104:107]
    ds_read_b64_tr_b16 v[192:193], v248 offset:10240
    v_mfma_f32_16x16x32_bf16 v[108:111], v[172:175], v[196:199], v[108:111]
    ds_read_b64_tr_b16 v[194:195], v248 offset:11520
    s_waitcnt lgkmcnt(7)
    v_mfma_f32_16x16x32_bf16 v[112:115], v[160:163], v[200:203], v[112:115]
    ds_read_b64_tr_b16 v[196:197], v249 offset:10272
    v_mfma_f32_16x16x32_bf16 v[116:119], v[164:167], v[200:203], v[116:119]
    ds_read_b64_tr_b16 v[198:199], v249 offset:11552
    v_mfma_f32_16x16x32_bf16 v[120:123], v[168:171], v[200:203], v[120:123]
    v_mfma_f32_16x16x32_bf16 v[124:127], v[172:175], v[200:203], v[124:127]
    ds_read_b64_tr_b16 v[200:201], v248 offset:10304
    v_mfma_f32_16x16x32_bf16 v[128:131], v[160:163], v[204:207], v[128:131]
    ds_read_b64_tr_b16 v[202:203], v248 offset:11584
    v_mfma_f32_16x16x32_bf16 v[132:135], v[164:167], v[204:207], v[132:135]
    v_mfma_f32_16x16x32_bf16 v[136:139], v[168:171], v[204:207], v[136:139]
    v_mfma_f32_16x16x32_bf16 v[140:143], v[172:175], v[204:207], v[140:143]
    ds_read_b64_tr_b16 v[204:205], v249 offset:10336
    s_waitcnt lgkmcnt(7)
    v_mfma_f32_16x16x32_bf16 v[144:147], v[160:163], v[208:211], v[144:147]
    ds_read_b64_tr_b16 v[206:207], v249 offset:11616
    v_mfma_f32_16x16x32_bf16 v[148:151], v[164:167], v[208:211], v[148:151]
    v_mfma_f32_16x16x32_bf16 v[152:155], v[168:171], v[208:211], v[152:155]
    v_mfma_f32_16x16x32_bf16 v[156:159], v[172:175], v[208:211], v[156:159]
    ds_read_b64_tr_b16 v[208:209], v248 offset:10368
    s_waitcnt lgkmcnt(7)
    v_mfma_f32_16x16x32_bf16 v[80:83], v[176:179], v[192:195], v[80:83]
    ds_read_b64_tr_b16 v[210:211], v248 offset:11648
    v_mfma_f32_16x16x32_bf16 v[84:87], v[180:183], v[192:195], v[84:87]
    v_add_u32 v248, s29, v248
    v_add_u32 v249, s29, v249
    v_mfma_f32_16x16x32_bf16 v[88:91], v[184:187], v[192:195], v[88:91]
    v_add_u32 v250, s29, v250
    v_add_u32 v251, s29, v251
    v_mfma_f32_16x16x32_bf16 v[92:95], v[188:191], v[192:195], v[92:95]
    s_waitcnt lgkmcnt(6)
    v_mfma_f32_16x16x32_bf16 v[96:99], v[176:179], v[196:199], v[96:99]
    v_cvt_pk_bf16_f32 v80, v80, v81
    v_cvt_pk_bf16_f32 v81, v82, v83
    v_mfma_f32_16x16x32_bf16 v[100:103], v[180:183], v[196:199], v[100:103]
    v_cvt_pk_bf16_f32 v82, v84, v85
    v_cvt_pk_bf16_f32 v83, v86, v87
    v_mfma_f32_16x16x32_bf16 v[104:107], v[184:187], v[196:199], v[104:107]
    v_cvt_pk_bf16_f32 v88, v88, v89
    v_cvt_pk_bf16_f32 v89, v90, v91
    v_mfma_f32_16x16x32_bf16 v[108:111], v[188:191], v[196:199], v[108:111]
    s_waitcnt lgkmcnt(0)
    s_barrier
    v_mfma_f32_16x16x32_bf16 v[112:115], v[176:179], v[200:203], v[112:115]
    ds_read_b128 v[212:215], v252 offset:0
    v_cvt_pk_bf16_f32 v90, v92, v93
    v_mfma_f32_16x16x32_bf16 v[116:119], v[180:183], v[200:203], v[116:119]
    ds_read_b128 v[216:219], v252 offset:1024
    v_cvt_pk_bf16_f32 v91, v94, v95
    v_mfma_f32_16x16x32_bf16 v[120:123], v[184:187], v[200:203], v[120:123]
    ds_read_b128 v[220:223], v252 offset:2048
    v_cvt_pk_bf16_f32 v96, v96, v97
    v_mfma_f32_16x16x32_bf16 v[124:127], v[188:191], v[200:203], v[124:127]
    ds_read_b128 v[224:227], v252 offset:3072
    v_cvt_pk_bf16_f32 v97, v98, v99
    v_mfma_f32_16x16x32_bf16 v[128:131], v[176:179], v[204:207], v[128:131]
    ds_read_b128 v[160:163], v250 offset:0
    v_cvt_pk_bf16_f32 v98, v100, v101
    v_mfma_f32_16x16x32_bf16 v[132:135], v[180:183], v[204:207], v[132:135]
    ds_read_b64_tr_b16 v[192:193], v248 offset:0
    v_cvt_pk_bf16_f32 v99, v102, v103
    v_mfma_f32_16x16x32_bf16 v[136:139], v[184:187], v[204:207], v[136:139]
    ds_read_b64_tr_b16 v[194:195], v248 offset:1280
    v_cvt_pk_bf16_f32 v104, v104, v105
    v_mfma_f32_16x16x32_bf16 v[140:143], v[188:191], v[204:207], v[140:143]
    ds_read_b128 v[164:167], v250 offset:2048
    v_cvt_pk_bf16_f32 v105, v106, v107
    v_mfma_f32_16x16x32_bf16 v[144:147], v[176:179], v[208:211], v[144:147]
    ds_read_b128 v[168:171], v250 offset:4096
    v_cvt_pk_bf16_f32 v106, v108, v109
    v_mfma_f32_16x16x32_bf16 v[148:151], v[180:183], v[208:211], v[148:151]
    ds_read_b128 v[172:175], v250 offset:6144
    v_cvt_pk_bf16_f32 v107, v110, v111
    v_mfma_f32_16x16x32_bf16 v[152:155], v[184:187], v[208:211], v[152:155]
    ds_read_b64_tr_b16 v[196:197], v249 offset:32
    v_xor_b32 v252, 8192, v252
    v_mfma_f32_16x16x32_bf16 v[156:159], v[188:191], v[208:211], v[156:159]
    ds_read_b64_tr_b16 v[198:199], v249 offset:1312
    v_cvt_pk_bf16_f32 v112, v112, v113
    s_waitcnt lgkmcnt(7)
    v_mfma_f32_16x16x32_bf16 v[0:3], v[80:83], v[212:215], v[0:3]
    ds_read_b64_tr_b16 v[200:201], v248 offset:64
    v_cvt_pk_bf16_f32 v113, v114, v115
    v_mfma_f32_16x16x32_bf16 v[4:7], v[80:83], v[216:219], v[4:7]
    ds_read_b64_tr_b16 v[202:203], v248 offset:1344
    v_cvt_pk_bf16_f32 v114, v116, v117
    v_mfma_f32_16x16x32_bf16 v[8:11], v[88:91], v[220:223], v[8:11]
    ds_read_b64_tr_b16 v[204:205], v249 offset:96
    v_cvt_pk_bf16_f32 v115, v118, v119
    v_mfma_f32_16x16x32_bf16 v[12:15], v[88:91], v[224:227], v[12:15]
    ds_read_b64_tr_b16 v[206:207], v249 offset:1376
    v_cvt_pk_bf16_f32 v120, v120, v121
    v_mfma_f32_16x16x32_bf16 v[16:19], v[96:99], v[212:215], v[16:19]
    ds_read_b64_tr_b16 v[208:209], v248 offset:128
    v_cvt_pk_bf16_f32 v121, v122, v123
    v_mfma_f32_16x16x32_bf16 v[20:23], v[96:99], v[216:219], v[20:23]
    ds_read_b64_tr_b16 v[210:211], v248 offset:1408
    v_cvt_pk_bf16_f32 v122, v124, v125
    v_mfma_f32_16x16x32_bf16 v[24:27], v[104:107], v[220:223], v[24:27]
    ds_read_b128 v[176:179], v251 offset:0
    v_cvt_pk_bf16_f32 v123, v126, v127
    v_mfma_f32_16x16x32_bf16 v[28:31], v[104:107], v[224:227], v[28:31]
    ds_read_b128 v[180:183], v251 offset:2048
    v_cvt_pk_bf16_f32 v128, v128, v129
    v_mfma_f32_16x16x32_bf16 v[32:35], v[112:115], v[212:215], v[32:35]
    ds_read_b128 v[184:187], v251 offset:4096
    v_cvt_pk_bf16_f32 v129, v130, v131
    v_mfma_f32_16x16x32_bf16 v[36:39], v[112:115], v[216:219], v[36:39]
    ds_read_b128 v[188:191], v251 offset:6144
    v_cvt_pk_bf16_f32 v130, v132, v133
    v_mfma_f32_16x16x32_bf16 v[40:43], v[120:123], v[220:223], v[40:43]
    v_cvt_pk_bf16_f32 v131, v134, v135
    v_cvt_pk_bf16_f32 v136, v136, v137
    v_mfma_f32_16x16x32_bf16 v[44:47], v[120:123], v[224:227], v[44:47]
    v_cvt_pk_bf16_f32 v137, v138, v139
    v_cvt_pk_bf16_f32 v138, v140, v141
    v_mfma_f32_16x16x32_bf16 v[48:51], v[128:131], v[212:215], v[48:51]
    v_cvt_pk_bf16_f32 v139, v142, v143
    v_cvt_pk_bf16_f32 v144, v144, v145
    v_mfma_f32_16x16x32_bf16 v[52:55], v[128:131], v[216:219], v[52:55]
    v_cvt_pk_bf16_f32 v145, v146, v147
    v_cvt_pk_bf16_f32 v146, v148, v149
    v_mfma_f32_16x16x32_bf16 v[56:59], v[136:139], v[220:223], v[56:59]
    v_cvt_pk_bf16_f32 v147, v150, v151
    v_cvt_pk_bf16_f32 v152, v152, v153
    v_mfma_f32_16x16x32_bf16 v[60:63], v[136:139], v[224:227], v[60:63]
    v_cvt_pk_bf16_f32 v153, v154, v155
    v_cvt_pk_bf16_f32 v154, v156, v157
    v_mfma_f32_16x16x32_bf16 v[64:67], v[144:147], v[212:215], v[64:67]
    v_cvt_pk_bf16_f32 v155, v158, v159
    s_add_u32 s28, s28, 1
    v_mfma_f32_16x16x32_bf16 v[68:71], v[144:147], v[216:219], v[68:71]
    s_cmp_lt_u32 s28, 6
    v_mfma_f32_16x16x32_bf16 v[72:75], v[152:155], v[220:223], v[72:75]
    v_mfma_f32_16x16x32_bf16 v[76:79], v[152:155], v[224:227], v[76:79]
    s_cbranch_scc1 L_c2
    s_waitcnt lgkmcnt(7)
    v_mfma_f32_16x16x32_bf16 v[80:83], v[160:163], v[192:195], 0
    v_mfma_f32_16x16x32_bf16 v[84:87], v[164:167], v[192:195], 0
    s_add_u32 s30, s30, 1
    v_mfma_f32_16x16x32_bf16 v[88:91], v[168:171], v[192:195], 0
    v_mfma_f32_16x16x32_bf16 v[92:95], v[172:175], v[192:195], 0
    ds_read_b64_tr_b16 v[192:193], v248 offset:10240
    s_cmp_eq_u32 s30, 4
    v_mfma_f32_16x16x32_bf16 v[96:99], v[160:163], v[196:199], 0
    ds_read_b64_tr_b16 v[194:195], v248 offset:11520
    v_mfma_f32_16x16x32_bf16 v[100:103], v[164:167], v[196:199], 0
    s_cselect_b32 s29, 4294856704, s31
    v_mfma_f32_16x16x32_bf16 v[104:107], v[168:171], v[196:199], 0
    v_mfma_f32_16x16x32_bf16 v[108:111], v[172:175], v[196:199], 0
    ds_read_b64_tr_b16 v[196:197], v249 offset:10272
    s_cselect_b32 s30, 0, s30
    v_mfma_f32_16x16x32_bf16 v[112:115], v[160:163], v[200:203], 0
    ds_read_b64_tr_b16 v[198:199], v249 offset:11552
    v_mfma_f32_16x16x32_bf16 v[116:119], v[164:167], v[200:203], 0
    v_mfma_f32_16x16x32_bf16 v[120:123], v[168:171], v[200:203], 0
    v_mfma_f32_16x16x32_bf16 v[124:127], v[172:175], v[200:203], 0
    ds_read_b64_tr_b16 v[200:201], v248 offset:10304
    s_waitcnt lgkmcnt(7)
    v_mfma_f32_16x16x32_bf16 v[128:131], v[160:163], v[204:207], 0
    ds_read_b64_tr_b16 v[202:203], v248 offset:11584
    v_mfma_f32_16x16x32_bf16 v[132:135], v[164:167], v[204:207], 0
    v_mfma_f32_16x16x32_bf16 v[136:139], v[168:171], v[204:207], 0
    v_mfma_f32_16x16x32_bf16 v[140:143], v[172:175], v[204:207], 0
    ds_read_b64_tr_b16 v[204:205], v249 offset:10336
    v_mfma_f32_16x16x32_bf16 v[144:147], v[160:163], v[208:211], 0
    ds_read_b64_tr_b16 v[206:207], v249 offset:11616
    v_mfma_f32_16x16x32_bf16 v[148:151], v[164:167], v[208:211], 0
    v_mfma_f32_16x16x32_bf16 v[152:155], v[168:171], v[208:211], 0
    v_mfma_f32_16x16x32_bf16 v[156:159], v[172:175], v[208:211], 0
    ds_read_b64_tr_b16 v[208:209], v248 offset:10368
    s_waitcnt lgkmcnt(7)
    v_mfma_f32_16x16x32_bf16 v[80:83], v[176:179], v[192:195], v[80:83]
    ds_read_b64_tr_b16 v[210:211], v248 offset:11648
    v_mfma_f32_16x16x32_bf16 v[84:87], v[180:183], v[192:195], v[84:87]
    v_add_u32 v248, s29, v248
    v_add_u32 v249, s29, v249
    v_mfma_f32_16x16x32_bf16 v[88:91], v[184:187], v[192:195], v[88:91]
    v_add_u32 v250, s29, v250
    v_add_u32 v251, s29, v251
    v_mfma_f32_16x16x32_bf16 v[92:95], v[188:191], v[192:195], v[92:95]
    s_waitcnt lgkmcnt(6)
    v_mfma_f32_16x16x32_bf16 v[96:99], v[176:179], v[196:199], v[96:99]
    v_mfma_f32_16x16x32_bf16 v[100:103], v[180:183], v[196:199], v[100:103]
    v_mfma_f32_16x16x32_bf16 v[104:107], v[184:187], v[196:199], v[104:107]
    v_mfma_f32_16x16x32_bf16 v[108:111], v[188:191], v[196:199], v[108:111]
    s_waitcnt lgkmcnt(0)
    s_barrier
    v_mfma_f32_16x16x32_bf16 v[112:115], v[176:179], v[200:203], v[112:115]
    ds_read_b128 v[160:163], v250 offset:0
    v_mfma_f32_16x16x32_bf16 v[116:119], v[180:183], v[200:203], v[116:119]
    ds_read_b64_tr_b16 v[192:193], v248 offset:0
    v_mfma_f32_16x16x32_bf16 v[120:123], v[184:187], v[200:203], v[120:123]
    ds_read_b64_tr_b16 v[194:195], v248 offset:1280
    v_mfma_f32_16x16x32_bf16 v[124:127], v[188:191], v[200:203], v[124:127]
    ds_read_b128 v[164:167], v250 offset:2048
    v_mfma_f32_16x16x32_bf16 v[128:131], v[176:179], v[204:207], v[128:131]
    ds_read_b128 v[168:171], v250 offset:4096
    v_mfma_f32_16x16x32_bf16 v[132:135], v[180:183], v[204:207], v[132:135]
    ds_read_b128 v[172:175], v250 offset:6144
    v_mfma_f32_16x16x32_bf16 v[136:139], v[184:187], v[204:207], v[136:139]
    ds_read_b64_tr_b16 v[196:197], v249 offset:32
    v_mfma_f32_16x16x32_bf16 v[140:143], v[188:191], v[204:207], v[140:143]
    ds_read_b64_tr_b16 v[198:199], v249 offset:1312
    v_mfma_f32_16x16x32_bf16 v[144:147], v[176:179], v[208:211], v[144:147]
    ds_read_b64_tr_b16 v[200:201], v248 offset:64
    v_mfma_f32_16x16x32_bf16 v[148:151], v[180:183], v[208:211], v[148:151]
    ds_read_b64_tr_b16 v[202:203], v248 offset:1344
    v_mfma_f32_16x16x32_bf16 v[152:155], v[184:187], v[208:211], v[152:155]
    ds_read_b64_tr_b16 v[204:205], v249 offset:96
    v_mfma_f32_16x16x32_bf16 v[156:159], v[188:191], v[208:211], v[156:159]
    ds_read_b64_tr_b16 v[206:207], v249 offset:1376
    s_waitcnt lgkmcnt(9)
    v_mfma_f32_16x16x32_bf16 v[80:83], v[160:163], v[192:195], v[80:83]
    ds_read_b64_tr_b16 v[208:209], v248 offset:128
    s_mul_i32 s76, s23, 40960
    s_waitcnt lgkmcnt(9)
    v_mfma_f32_16x16x32_bf16 v[84:87], v[164:167], v[192:195], v[84:87]
    ds_read_b64_tr_b16 v[210:211], v248 offset:1408
    s_mul_i32 s24, s19, 10240
    s_waitcnt lgkmcnt(9)
    v_mfma_f32_16x16x32_bf16 v[88:91], v[168:171], v[192:195], v[88:91]
    ds_read_b128 v[176:179], v251 offset:0
    s_add_u32 s76, s76, s24
    s_waitcnt lgkmcnt(9)
    v_mfma_f32_16x16x32_bf16 v[92:95], v[172:175], v[192:195], v[92:95]
    ds_read_b128 v[180:183], v251 offset:2048
    s_add_u32 s77, s76, 4096
    s_waitcnt lgkmcnt(8)
    v_mfma_f32_16x16x32_bf16 v[96:99], v[160:163], v[196:199], v[96:99]
    ds_read_b128 v[184:187], v251 offset:4096
    s_add_u32 s78, s76, 8192
    v_mfma_f32_16x16x32_bf16 v[100:103], v[164:167], v[196:199], v[100:103]
    ds_read_b128 v[188:191], v251 offset:6144
    s_cmp_eq_u32 s23, s19
    v_mfma_f32_16x16x32_bf16 v[104:107], v[168:171], v[196:199], v[104:107]
    ds_read_b64_tr_b16 v[192:193], v248 offset:10240
    v_mfma_f32_16x16x32_bf16 v[108:111], v[172:175], v[196:199], v[108:111]
    ds_read_b64_tr_b16 v[194:195], v248 offset:11520
    s_waitcnt lgkmcnt(7)
    v_mfma_f32_16x16x32_bf16 v[112:115], v[160:163], v[200:203], v[112:115]
    ds_read_b64_tr_b16 v[196:197], v249 offset:10272
    v_mfma_f32_16x16x32_bf16 v[116:119], v[164:167], v[200:203], v[116:119]
    ds_read_b64_tr_b16 v[198:199], v249 offset:11552
    v_mfma_f32_16x16x32_bf16 v[120:123], v[168:171], v[200:203], v[120:123]
    v_mfma_f32_16x16x32_bf16 v[124:127], v[172:175], v[200:203], v[124:127]
    ds_read_b64_tr_b16 v[200:201], v248 offset:10304
    v_mfma_f32_16x16x32_bf16 v[128:131], v[160:163], v[204:207], v[128:131]
    ds_read_b64_tr_b16 v[202:203], v248 offset:11584
    v_mfma_f32_16x16x32_bf16 v[132:135], v[164:167], v[204:207], v[132:135]
    v_mfma_f32_16x16x32_bf16 v[136:139], v[168:171], v[204:207], v[136:139]
    v_mfma_f32_16x16x32_bf16 v[140:143], v[172:175], v[204:207], v[140:143]
    ds_read_b64_tr_b16 v[204:205], v249 offset:10336
    s_waitcnt lgkmcnt(7)
    v_mfma_f32_16x16x32_bf16 v[144:147], v[160:163], v[208:211], v[144:147]
    ds_read_b64_tr_b16 v[206:207], v249 offset:11616
    v_mfma_f32_16x16x32_bf16 v[148:151], v[164:167], v[208:211], v[148:151]
    v_mfma_f32_16x16x32_bf16 v[152:155], v[168:171], v[208:211], v[152:155]
    v_mfma_f32_16x16x32_bf16 v[156:159], v[172:175], v[208:211], v[156:159]
    ds_read_b64_tr_b16 v[208:209], v248 offset:10368
    s_waitcnt lgkmcnt(7)
    v_mfma_f32_16x16x32_bf16 v[80:83], v[176:179], v[192:195], v[80:83]
    ds_read_b64_tr_b16 v[210:211], v248 offset:11648
    v_mfma_f32_16x16x32_bf16 v[84:87], v[180:183], v[192:195], v[84:87]
    v_mfma_f32_16x16x32_bf16 v[88:91], v[184:187], v[192:195], v[88:91]
    v_mfma_f32_16x16x32_bf16 v[92:95], v[188:191], v[192:195], v[92:95]
    s_waitcnt lgkmcnt(6)
    v_mfma_f32_16x16x32_bf16 v[96:99], v[176:179], v[196:199], v[96:99]
    s_nop 1
    v_cvt_pk_bf16_f32 v80, v80, v81
    v_cvt_pk_bf16_f32 v81, v82, v83
    v_mfma_f32_16x16x32_bf16 v[100:103], v[180:183], v[196:199], v[100:103]
    v_cvt_pk_bf16_f32 v82, v84, v85
    v_cvt_pk_bf16_f32 v83, v86, v87
    v_mfma_f32_16x16x32_bf16 v[104:107], v[184:187], v[196:199], v[104:107]
    v_cvt_pk_bf16_f32 v88, v88, v89
    v_cvt_pk_bf16_f32 v89, v90, v91
    v_mfma_f32_16x16x32_bf16 v[108:111], v[188:191], v[196:199], v[108:111]
    v_cvt_pk_bf16_f32 v90, v92, v93
    v_cvt_pk_bf16_f32 v91, v94, v95
    s_waitcnt lgkmcnt(4)
    v_mfma_f32_16x16x32_bf16 v[112:115], v[176:179], v[200:203], v[112:115]
    ds_read_b128 v[212:215], v252 offset:0
    v_cvt_pk_bf16_f32 v96, v96, v97
    v_mfma_f32_16x16x32_bf16 v[116:119], v[180:183], v[200:203], v[116:119]
    ds_read_b128 v[216:219], v252 offset:1024
    v_cvt_pk_bf16_f32 v97, v98, v99
    v_mfma_f32_16x16x32_bf16 v[120:123], v[184:187], v[200:203], v[120:123]
    ds_read_b128 v[220:223], v252 offset:2048
    v_cvt_pk_bf16_f32 v98, v100, v101
    v_mfma_f32_16x16x32_bf16 v[124:127], v[188:191], v[200:203], v[124:127]
    ds_read_b128 v[224:227], v252 offset:3072
    v_cvt_pk_bf16_f32 v99, v102, v103
    s_waitcnt lgkmcnt(6)
    v_mfma_f32_16x16x32_bf16 v[128:131], v[176:179], v[204:207], v[128:131]
    v_cvt_pk_bf16_f32 v104, v104, v105
    v_cvt_pk_bf16_f32 v105, v106, v107
    v_mfma_f32_16x16x32_bf16 v[132:135], v[180:183], v[204:207], v[132:135]
    v_cvt_pk_bf16_f32 v106, v108, v109
    v_cvt_pk_bf16_f32 v107, v110, v111
    v_mfma_f32_16x16x32_bf16 v[136:139], v[184:187], v[204:207], v[136:139]
    v_cvt_pk_bf16_f32 v112, v112, v113
    v_cvt_pk_bf16_f32 v113, v114, v115
    v_mfma_f32_16x16x32_bf16 v[140:143], v[188:191], v[204:207], v[140:143]
    v_cvt_pk_bf16_f32 v114, v116, v117
    v_cvt_pk_bf16_f32 v115, v118, v119
    s_waitcnt lgkmcnt(4)
    v_mfma_f32_16x16x32_bf16 v[144:147], v[176:179], v[208:211], v[144:147]
    v_cvt_pk_bf16_f32 v120, v120, v121
    v_cvt_pk_bf16_f32 v121, v122, v123
    v_mfma_f32_16x16x32_bf16 v[148:151], v[180:183], v[208:211], v[148:151]
    v_cvt_pk_bf16_f32 v122, v124, v125
    v_cvt_pk_bf16_f32 v123, v126, v127
    v_mfma_f32_16x16x32_bf16 v[152:155], v[184:187], v[208:211], v[152:155]
    v_cvt_pk_bf16_f32 v128, v128, v129
    v_cvt_pk_bf16_f32 v129, v130, v131
    v_mfma_f32_16x16x32_bf16 v[156:159], v[188:191], v[208:211], v[156:159]
    v_cvt_pk_bf16_f32 v130, v132, v133
    v_cvt_pk_bf16_f32 v131, v134, v135
    s_cbranch_scc1 L_keeper
    s_waitcnt lgkmcnt(3)
    v_mfma_f32_16x16x32_bf16 v[0:3], v[80:83], v[212:215], v[0:3]
    v_cvt_pk_bf16_f32 v136, v136, v137
    v_cvt_pk_bf16_f32 v137, v138, v139
    s_waitcnt lgkmcnt(2)
    v_mfma_f32_16x16x32_bf16 v[4:7], v[80:83], v[216:219], v[4:7]
    v_cvt_pk_bf16_f32 v138, v140, v141
    v_cvt_pk_bf16_f32 v139, v142, v143
    s_waitcnt lgkmcnt(1)
    v_mfma_f32_16x16x32_bf16 v[8:11], v[88:91], v[220:223], v[8:11]
    v_cvt_pk_bf16_f32 v144, v144, v145
    v_cvt_pk_bf16_f32 v145, v146, v147
    s_waitcnt lgkmcnt(0)
    v_mfma_f32_16x16x32_bf16 v[12:15], v[88:91], v[224:227], v[12:15]
    v_cvt_pk_bf16_f32 v146, v148, v149
    v_cvt_pk_bf16_f32 v147, v150, v151
    v_mfma_f32_16x16x32_bf16 v[16:19], v[96:99], v[212:215], v[16:19]
    v_cvt_pk_bf16_f32 v152, v152, v153
    v_cvt_pk_bf16_f32 v153, v154, v155
    v_cvt_pk_bf16_f32 v160, v0, v1
    v_cvt_pk_bf16_f32 v161, v2, v3
    v_cvt_pk_bf16_f32 v162, v4, v5
    v_cvt_pk_bf16_f32 v163, v6, v7
    buffer_store_dwordx4 v[160:163], v244, s[64:67], s76 offen offset:0 sc1
    v_mfma_f32_16x16x32_bf16 v[20:23], v[96:99], v[216:219], v[20:23]
    v_cvt_pk_bf16_f32 v154, v156, v157
    v_cvt_pk_bf16_f32 v155, v158, v159
    v_mfma_f32_16x16x32_bf16 v[24:27], v[104:107], v[220:223], v[24:27]
    v_cvt_pk_bf16_f32 v164, v8, v9
    v_cvt_pk_bf16_f32 v165, v10, v11
    v_cvt_pk_bf16_f32 v166, v12, v13
    v_cvt_pk_bf16_f32 v167, v14, v15
    buffer_store_dwordx4 v[164:167], v244, s[64:67], s76 offen offset:1024 sc1
    v_mfma_f32_16x16x32_bf16 v[28:31], v[104:107], v[224:227], v[28:31]
    v_mfma_f32_16x16x32_bf16 v[32:35], v[112:115], v[212:215], v[32:35]
    v_cvt_pk_bf16_f32 v168, v16, v17
    v_cvt_pk_bf16_f32 v169, v18, v19
    v_cvt_pk_bf16_f32 v170, v20, v21
    v_cvt_pk_bf16_f32 v171, v22, v23
    buffer_store_dwordx4 v[168:171], v244, s[64:67], s76 offen offset:2048 sc1
    v_mfma_f32_16x16x32_bf16 v[36:39], v[112:115], v[216:219], v[36:39]
    v_mfma_f32_16x16x32_bf16 v[40:43], v[120:123], v[220:223], v[40:43]
    v_cvt_pk_bf16_f32 v172, v24, v25
    v_cvt_pk_bf16_f32 v173, v26, v27
    v_cvt_pk_bf16_f32 v174, v28, v29
    v_cvt_pk_bf16_f32 v175, v30, v31
    buffer_store_dwordx4 v[172:175], v244, s[64:67], s76 offen offset:3072 sc1
    v_mfma_f32_16x16x32_bf16 v[44:47], v[120:123], v[224:227], v[44:47]
    v_mfma_f32_16x16x32_bf16 v[48:51], v[128:131], v[212:215], v[48:51]
    v_cvt_pk_bf16_f32 v176, v32, v33
    v_cvt_pk_bf16_f32 v177, v34, v35
    v_cvt_pk_bf16_f32 v178, v36, v37
    v_cvt_pk_bf16_f32 v179, v38, v39
    buffer_store_dwordx4 v[176:179], v244, s[64:67], s77 offen offset:0 sc1
    v_mfma_f32_16x16x32_bf16 v[52:55], v[128:131], v[216:219], v[52:55]
    v_mfma_f32_16x16x32_bf16 v[56:59], v[136:139], v[220:223], v[56:59]
    v_cvt_pk_bf16_f32 v180, v40, v41
    v_cvt_pk_bf16_f32 v181, v42, v43
    v_cvt_pk_bf16_f32 v182, v44, v45
    v_cvt_pk_bf16_f32 v183, v46, v47
    buffer_store_dwordx4 v[180:183], v244, s[64:67], s77 offen offset:1024 sc1
    v_mfma_f32_16x16x32_bf16 v[60:63], v[136:139], v[224:227], v[60:63]
    v_mfma_f32_16x16x32_bf16 v[64:67], v[144:147], v[212:215], v[64:67]
    v_cvt_pk_bf16_f32 v184, v48, v49
    v_cvt_pk_bf16_f32 v185, v50, v51
    v_cvt_pk_bf16_f32 v186, v52, v53
    v_cvt_pk_bf16_f32 v187, v54, v55
    buffer_store_dwordx4 v[184:187], v244, s[64:67], s77 offen offset:2048 sc1
    v_mfma_f32_16x16x32_bf16 v[68:71], v[144:147], v[216:219], v[68:71]
    v_mfma_f32_16x16x32_bf16 v[72:75], v[152:155], v[220:223], v[72:75]
    v_cvt_pk_bf16_f32 v188, v56, v57
    v_cvt_pk_bf16_f32 v189, v58, v59
    v_cvt_pk_bf16_f32 v190, v60, v61
    v_cvt_pk_bf16_f32 v191, v62, v63
    buffer_store_dwordx4 v[188:191], v244, s[64:67], s77 offen offset:3072 sc1
    v_mfma_f32_16x16x32_bf16 v[76:79], v[152:155], v[224:227], v[76:79]
    v_cvt_pk_bf16_f32 v192, v64, v65
    v_cvt_pk_bf16_f32 v193, v66, v67
    v_cvt_pk_bf16_f32 v194, v68, v69
    v_cvt_pk_bf16_f32 v195, v70, v71
    buffer_store_dwordx4 v[192:195], v244, s[64:67], s78 offen offset:0 sc1
    v_cvt_pk_bf16_f32 v196, v72, v73
    v_cvt_pk_bf16_f32 v197, v74, v75
    s_nop 0
    v_cvt_pk_bf16_f32 v198, v76, v77
    v_cvt_pk_bf16_f32 v199, v78, v79
    buffer_store_dwordx4 v[196:199], v244, s[64:67], s78 offen offset:1024 sc1
    s_barrier
    s_and_b32 s24, s2, 0xfc
    s_add_u32 s24, s24, s23
    s_lshl_b32 s24, s24, 7
    s_lshl_b32 s25, s19, 2
    s_add_u32 s24, s24, s25
    s_add_u32 s24, s24, 32768
    s_waitcnt vmcnt(0)
    buffer_store_dword v253, v254, s[72:75], s24 offen sc1
    s_endpgm
L_keeper:
    s_waitcnt lgkmcnt(3)
    v_mfma_f32_16x16x32_bf16 v[0:3], v[80:83], v[212:215], v[0:3]
    v_cvt_pk_bf16_f32 v136, v136, v137
    v_cvt_pk_bf16_f32 v137, v138, v139
    s_waitcnt lgkmcnt(2)
    v_mfma_f32_16x16x32_bf16 v[4:7], v[80:83], v[216:219], v[4:7]
    v_cvt_pk_bf16_f32 v138, v140, v141
    v_cvt_pk_bf16_f32 v139, v142, v143
    s_waitcnt lgkmcnt(1)
    v_mfma_f32_16x16x32_bf16 v[8:11], v[88:91], v[220:223], v[8:11]
    v_cvt_pk_bf16_f32 v144, v144, v145
    v_cvt_pk_bf16_f32 v145, v146, v147
    s_waitcnt lgkmcnt(0)
    v_mfma_f32_16x16x32_bf16 v[12:15], v[88:91], v[224:227], v[12:15]
    v_cvt_pk_bf16_f32 v146, v148, v149
    v_cvt_pk_bf16_f32 v147, v150, v151
    v_mfma_f32_16x16x32_bf16 v[16:19], v[96:99], v[212:215], v[16:19]
    v_cvt_pk_bf16_f32 v152, v152, v153
    v_cvt_pk_bf16_f32 v153, v154, v155
    ds_write_b128 v244, v[0:3] offset:0
    v_mfma_f32_16x16x32_bf16 v[20:23], v[96:99], v[216:219], v[20:23]
    v_cvt_pk_bf16_f32 v154, v156, v157
    v_cvt_pk_bf16_f32 v155, v158, v159
    ds_write_b128 v244, v[4:7] offset:1024
    v_mfma_f32_16x16x32_bf16 v[24:27], v[104:107], v[220:223], v[24:27]
    ds_write_b128 v244, v[8:11] offset:2048
    v_mfma_f32_16x16x32_bf16 v[28:31], v[104:107], v[224:227], v[28:31]
    ds_write_b128 v244, v[12:15] offset:3072
    v_mfma_f32_16x16x32_bf16 v[32:35], v[112:115], v[212:215], v[32:35]
    ds_write_b128 v244, v[16:19] offset:4096
    v_mfma_f32_16x16x32_bf16 v[36:39], v[112:115], v[216:219], v[36:39]
    ds_write_b128 v244, v[20:23] offset:5120
    v_mfma_f32_16x16x32_bf16 v[40:43], v[120:123], v[220:223], v[40:43]
    ds_write_b128 v244, v[24:27] offset:6144
    v_mfma_f32_16x16x32_bf16 v[44:47], v[120:123], v[224:227], v[44:47]
    ds_write_b128 v244, v[28:31] offset:7168
    v_mfma_f32_16x16x32_bf16 v[48:51], v[128:131], v[212:215], v[48:51]
    ds_write_b128 v244, v[32:35] offset:8192
    v_mfma_f32_16x16x32_bf16 v[52:55], v[128:131], v[216:219], v[52:55]
    ds_write_b128 v244, v[36:39] offset:9216
    v_mfma_f32_16x16x32_bf16 v[56:59], v[136:139], v[220:223], v[56:59]
    ds_write_b128 v244, v[40:43] offset:10240
    v_mfma_f32_16x16x32_bf16 v[60:63], v[136:139], v[224:227], v[60:63]
    ds_write_b128 v244, v[44:47] offset:11264
    v_mfma_f32_16x16x32_bf16 v[64:67], v[144:147], v[212:215], v[64:67]
    ds_write_b128 v244, v[48:51] offset:12288
    v_mfma_f32_16x16x32_bf16 v[68:71], v[144:147], v[216:219], v[68:71]
    ds_write_b128 v244, v[52:55] offset:13312
    v_mfma_f32_16x16x32_bf16 v[72:75], v[152:155], v[220:223], v[72:75]
    ds_write_b128 v244, v[56:59] offset:14336
    v_mfma_f32_16x16x32_bf16 v[76:79], v[152:155], v[224:227], v[76:79]
    ds_write_b128 v244, v[60:63] offset:15360
    s_mov_b32 s24, 4
    s_lshl_b32 s80, s2, 7
    s_add_u32 s80, s80, 32768
    s_mov_b32 s82, 0x11111111
    s_lshl_b32 s82, s82, s19
    s_mov_b32 s83, s82
    s_mul_i32 s81, s19, 40960
    s_lshl_b32 s84, s24, 11
    s_add_u32 s81, s81, s84
    s_lshl_b32 s79, s24, 5
    s_add_u32 s85, s79, 81920
    s_xor_b32 s84, s19, 1
    s_mul_i32 s84, s84, 10240
    s_add_u32 s76, s81, s84
    s_xor_b32 s84, s19, 2
    s_mul_i32 s84, s84, 10240
    s_add_u32 s77, s81, s84
    s_xor_b32 s84, s19, 3
    s_mul_i32 s84, s84, 10240
    s_add_u32 s78, s81, s84
    v_bfe_u32 v230, v244, 4, 5
    v_mul_u32_u24 v228, 2560, v230
    v_lshrrev_b32 v230, 9, v244
    v_lshl_add_u32 v228, v230, 4, v228
    v_lshrrev_b32 v230, 2, v244
    v_and_b32 v230, 12, v230
    s_waitcnt lgkmcnt(0)
    s_barrier
    s_mov_b32 s86, 0
L_xspin_k:
    buffer_load_dword v231, v230, s[72:75], s80 offen sc1
    s_waitcnt vmcnt(0)
L_xspin_k_chk:
    v_cmp_eq_u32 vcc, s27, v231
    s_add_u32 s86, s86, 1
    s_nop 2
    s_or_b64 vcc, vcc, s[82:83]
    s_cmp_eq_u64 vcc, -1
    s_cbranch_scc1 L_xspin_k_ok
    s_cmp_lt_u32 s86, 200000
    s_cbranch_scc1 L_xspin_k
L_xspin_k_ok:
    buffer_load_dwordx4 v[160:163], v244, s[64:67], s76 offen offset:0 sc1
    buffer_load_dwordx4 v[164:167], v244, s[64:67], s76 offen offset:1024 sc1
    buffer_load_dwordx4 v[168:171], v244, s[64:67], s77 offen offset:0 sc1
    buffer_load_dwordx4 v[172:175], v244, s[64:67], s77 offen offset:1024 sc1
    buffer_load_dwordx4 v[176:179], v244, s[64:67], s78 offen offset:0 sc1
    buffer_load_dwordx4 v[180:183], v244, s[64:67], s78 offen offset:1024 sc1
    s_mov_b32 s86, 0
    s_waitcnt vmcnt(4)
    v_lshlrev_b32 v232, 16, v160
    v_and_b32 v233, 0xffff0000, v160
    v_pk_add_f32 v[64:65], v[64:65], v[232:233]
    v_lshlrev_b32 v234, 16, v161
    v_and_b32 v235, 0xffff0000, v161
    v_pk_add_f32 v[66:67], v[66:67], v[234:235]
    v_lshlrev_b32 v232, 16, v162
    v_and_b32 v233, 0xffff0000, v162
    v_pk_add_f32 v[68:69], v[68:69], v[232:233]
    v_lshlrev_b32 v234, 16, v163
    v_and_b32 v235, 0xffff0000, v163
    v_pk_add_f32 v[70:71], v[70:71], v[234:235]
    v_lshlrev_b32 v232, 16, v164
    v_and_b32 v233, 0xffff0000, v164
    v_pk_add_f32 v[72:73], v[72:73], v[232:233]
    v_lshlrev_b32 v234, 16, v165
    v_and_b32 v235, 0xffff0000, v165
    v_pk_add_f32 v[74:75], v[74:75], v[234:235]
    v_lshlrev_b32 v232, 16, v166
    v_and_b32 v233, 0xffff0000, v166
    v_pk_add_f32 v[76:77], v[76:77], v[232:233]
    v_lshlrev_b32 v234, 16, v167
    v_and_b32 v235, 0xffff0000, v167
    v_pk_add_f32 v[78:79], v[78:79], v[234:235]
    s_waitcnt vmcnt(2)
    v_lshlrev_b32 v232, 16, v168
    v_and_b32 v233, 0xffff0000, v168
    v_pk_add_f32 v[64:65], v[64:65], v[232:233]
    v_lshlrev_b32 v234, 16, v169
    v_and_b32 v235, 0xffff0000, v169
    v_pk_add_f32 v[66:67], v[66:67], v[234:235]
    v_lshlrev_b32 v232, 16, v170
    v_and_b32 v233, 0xffff0000, v170
    v_pk_add_f32 v[68:69], v[68:69], v[232:233]
    v_lshlrev_b32 v234, 16, v171
    v_and_b32 v235, 0xffff0000, v171
    v_pk_add_f32 v[70:71], v[70:71], v[234:235]
    v_lshlrev_b32 v232, 16, v172
    v_and_b32 v233, 0xffff0000, v172
    v_pk_add_f32 v[72:73], v[72:73], v[232:233]
    v_lshlrev_b32 v234, 16, v173
    v_and_b32 v235, 0xffff0000, v173
    v_pk_add_f32 v[74:75], v[74:75], v[234:235]
    v_lshlrev_b32 v232, 16, v174
    v_and_b32 v233, 0xffff0000, v174
    v_pk_add_f32 v[76:77], v[76:77], v[232:233]
    v_lshlrev_b32 v234, 16, v175
    v_and_b32 v235, 0xffff0000, v175
    v_pk_add_f32 v[78:79], v[78:79], v[234:235]
    s_waitcnt vmcnt(0)
    v_lshlrev_b32 v232, 16, v176
    v_and_b32 v233, 0xffff0000, v176
    v_pk_add_f32 v[64:65], v[64:65], v[232:233]
    v_lshlrev_b32 v234, 16, v177
    v_and_b32 v235, 0xffff0000, v177
    v_pk_add_f32 v[66:67], v[66:67], v[234:235]
    v_lshlrev_b32 v232, 16, v178
    v_and_b32 v233, 0xffff0000, v178
    v_pk_add_f32 v[68:69], v[68:69], v[232:233]
    v_lshlrev_b32 v234, 16, v179
    v_and_b32 v235, 0xffff0000, v179
    v_pk_add_f32 v[70:71], v[70:71], v[234:235]
    v_lshlrev_b32 v232, 16, v180
    v_and_b32 v233, 0xffff0000, v180
    v_pk_add_f32 v[72:73], v[72:73], v[232:233]
    v_lshlrev_b32 v234, 16, v181
    v_and_b32 v235, 0xffff0000, v181
    v_pk_add_f32 v[74:75], v[74:75], v[234:235]
    v_lshlrev_b32 v232, 16, v182
    v_and_b32 v233, 0xffff0000, v182
    v_pk_add_f32 v[76:77], v[76:77], v[232:233]
    v_lshlrev_b32 v234, 16, v183
    v_and_b32 v235, 0xffff0000, v183
    v_pk_add_f32 v[78:79], v[78:79], v[234:235]
    v_cvt_pk_bf16_f32 v64, v64, v65
    v_cvt_pk_bf16_f32 v65, v66, v67
    v_cvt_pk_bf16_f32 v66, v68, v69
    v_cvt_pk_bf16_f32 v67, v70, v71
    v_cvt_pk_bf16_f32 v68, v72, v73
    v_cvt_pk_bf16_f32 v69, v74, v75
    v_cvt_pk_bf16_f32 v70, v76, v77
    v_cvt_pk_bf16_f32 v71, v78, v79
    v_permlane16_swap_b32 v64, v66
    v_permlane16_swap_b32 v65, v67
    v_permlane16_swap_b32 v68, v70
    v_permlane16_swap_b32 v69, v71
    buffer_store_dwordx4 v[64:67], v228, s[68:71], s79 offen
    buffer_store_dwordx4 v[68:71], v228, s[68:71], s85 offen
    s_or_b32 s24, s19, s21
    s_cmp_eq_u32 s24, 0
    s_cbranch_scc0 L_kdone
    buffer_store_dword v253, v254, s[72:75], s26 offen sc1
L_kdone:
    s_endpgm
L_codeend:
.section .rodata,"a"
.p2align 6
.amdhsa_kernel concat_heads__gqa_block_cached__gqa_block_cached__near_ridge_kernel
  .amdhsa_next_free_vgpr 256
  .amdhsa_next_free_sgpr 100
  .amdhsa_accum_offset 256
  .amdhsa_group_segment_fixed_size 0
  .amdhsa_kernarg_size 104
  .amdhsa_user_sgpr_count 2
  .amdhsa_user_sgpr_kernarg_segment_ptr 1
  .amdhsa_system_sgpr_workgroup_id_x 1
.end_amdhsa_kernel
```
